```python
import torch

def _softmax(x, axis=-1):
    return torch.softmax(x, dim=axis)
def _gelu(x):
    return torch.nn.functional.gelu(x, approximate="tanh")
def _silu(x):
    return torch.nn.functional.silu(x)
def _sigmoid(x):
    return torch.sigmoid(x)
def _layernorm(x, axis=-1, eps=1e-5):
    m = x.mean(dim=axis, keepdim=True)
    v = x.var(dim=axis, keepdim=True, unbiased=False)
    return (x - m) / torch.sqrt(v + eps)
def _scatter_add(tgt, idx, src, axis=0):
    return tgt.clone().index_add_(axis, idx, src)
def _segment_sum(src, seg, n):
    out = torch.zeros((n,) + src.shape[1:], dtype=src.dtype)
    return out.index_add_(0, seg, src)
def _pad(x, pw):
    flat = tuple(v for pair in reversed(pw) for v in pair)
    return torch.nn.functional.pad(x, flat)

kernel_name = 'gated_mix__sliding_local_dilated__mixer_token_mlp__prompt'

def setup_inputs():

    _w = (lambda a: (lambda t: t.to(torch.bfloat16) if t.is_floating_point() else t)(torch.as_tensor(a)))
    def _A_setup():
        B, S, D = 1, 2048, 512
        return {
            "x": _w((lambda *s: torch.randn(*s, dtype=torch.bfloat16) * 0.05)(B, S, D)),
            "wqkv": _w((lambda *s: torch.randn(*s, dtype=torch.bfloat16) * 0.8)(D, 3 * D)),
            "wo": _w((lambda *s: torch.randn(*s, dtype=torch.bfloat16) * 0.05)(D, D)),
        }
    _A_in = _A_setup()

    def _B_setup():
        B, S, D, F = 1, 2048, 512, 1792
        return {
            "x": _w((lambda *s: torch.randn(*s, dtype=torch.bfloat16) * 0.05)(B, S, D)),
            "w1": _w((lambda *s: torch.randn(*s, dtype=torch.bfloat16) * 1.6)(S, F) * (S ** -0.5)),
            "b1": _w((lambda *s: torch.randn(*s, dtype=torch.bfloat16) * 12.8)(F) * 0.02),
            "w2": _w((lambda *s: torch.randn(*s, dtype=torch.bfloat16) * 0.4)(F, S) * (F ** -0.5)),
            "b2": _w((lambda *s: torch.randn(*s, dtype=torch.bfloat16) * 6.4)(S) * 0.02),
        }
    _B_in = _B_setup()

    return {
        "A_x": _A_in["x"],
        "A_wqkv": _A_in["wqkv"],
        "A_wo": _A_in["wo"],
        "B_x": _B_in["x"],
        "B_w1": _B_in["w1"],
        "B_b1": _B_in["b1"],
        "B_w2": _B_in["w2"],
        "B_b2": _B_in["b2"],
        "gate_w": _w((lambda *s: torch.randn(*s, dtype=torch.bfloat16) * 0.05)(512) * 16.0),
    }

def reference(A_x, A_wqkv, A_wo, B_x, B_w1, B_b1, B_w2, B_b2, gate_w):
    def _A_ref(x, wqkv, wo):
        B, S, D = x.shape
        H = 32; Dh = D // H
        W, dil = 8, 2
        qkv = (lambda x, *d: x.permute(*d))((x @ wqkv).reshape(B, S, 3, H, Dh), 2, 0, 3, 1, 4)
        q, k, v = qkv[0], qkv[1], qkv[2]
        scale = Dh ** -0.5
        pos = torch.arange(S)
        off = torch.arange(W) * dil
        idx = pos[:, None] - off[None, :]
        mask = idx >= 0
        idx_c = torch.where(mask, idx, 0).reshape(-1)
        kg = k[:, :, idx_c, :].reshape(B, H, S, W, Dh)
        vg = v[:, :, idx_c, :].reshape(B, H, S, W, Dh)
        logits = torch.einsum("bhsd,bhswd->bhsw", q, kg) * scale
        logits = torch.where(mask[None, None, :, :], logits, -1e9)
        attn = _softmax(logits, axis=-1)
        o = torch.einsum("bhsw,bhswd->bhsd", attn, vg)
        return (lambda x, *d: x.permute(*d))(o, 0, 2, 1, 3).reshape(B, S, D) @ wo

    def _B_ref(x, w1, b1, w2, b2):
        B, S, D = x.shape
        h = _layernorm(x, axis=-1)
        u = torch.einsum("bsd,sf->bdf", h, w1) + b1
        u = _gelu(u)
        y = torch.einsum("bdf,fs->bds", u, w2) + b2
        return (lambda x, *d: x.permute(*d))(y, 0, 2, 1)

    x = A_x
    g = _sigmoid((x * gate_w).sum(-1, keepdims=True))
    a = _A_ref(x, A_wqkv, A_wo)
    b = _B_ref(x, B_w1, B_b1, B_w2, B_b2)
    return g * a + (1 - g) * b
```

```asm
; @launch grid=(256,1,1) block=(768,1,1) lds=163840
.amdgcn_target "amdgcn-amd-amdhsa--gfx950"
    .text
    .globl gated_mix__sliding_local_dilated__mixer_token_mlp__prompt_kernel
    .p2align 8
    .type gated_mix__sliding_local_dilated__mixer_token_mlp__prompt_kernel,@function
gated_mix__sliding_local_dilated__mixer_token_mlp__prompt_kernel:
    s_cmp_ge_u32 s2, 256
    s_cbranch_scc1 L_done
    s_load_dwordx16 s[40:55], s[0:1], 0
    s_load_dwordx8 s[56:63], s[0:1], 64
    v_and_b32 v1, 63, v0
    v_lshrrev_b32 v3, 6, v0
    v_subrev_u32 v2, 4, v3
    v_cmp_gt_u32 vcc, 4, v3
    s_nop 1
    v_cndmask_b32 v2, v2, v3, vcc
    s_and_b32 s32, s2, 7
    s_lshr_b32 s33, s2, 3
    s_lshl_b32 s34, s32, 5
    s_add_u32 s34, s34, s33
    s_lshr_b32 s35, s34, 3
    s_lshl_b32 s35, s35, 6
    s_and_b32 s36, s34, 7
    s_mul_i32 s64, s32, 28
    s_add_u32 s64, s64, s33
    s_lshr_b32 s65, s64, 3
    s_lshl_b32 s65, s65, 7
    s_and_b32 s66, s64, 7
    v_readfirstlane_b32 s25, v2
    v_readfirstlane_b32 s27, v3
    s_waitcnt lgkmcnt(0)
    s_mov_b32 s8, s40
    s_mov_b32 s9, s41
    s_and_b32 s9, s9, 0xffff
    s_mov_b32 s10, 0x200000
    s_mov_b32 s11, 0x00020000
    s_cmp_lt_u32 s27, 4
    s_cbranch_scc1 L_consumer
    s_cmp_lg_u32 s25, 7
    s_cbranch_scc1 code_pf_done
    s_getpc_b64 s[68:69]
code_pf_pc:
    s_sub_u32 s68, s68, code_pf_pc-gated_mix__sliding_local_dilated__mixer_token_mlp__prompt_kernel
    s_subb_u32 s69, s69, 0
    s_and_b32 s69, s69, 0xffff
    s_mov_b32 s70, L_code_end-gated_mix__sliding_local_dilated__mixer_token_mlp__prompt_kernel
    s_mov_b32 s71, 0x00020000
    v_lshlrev_b32 v40, 6, v1
    buffer_load_dword v41, v40, s[68:71], 0 offen
    v_add_u32 v40, 4096, v40
    buffer_load_dword v41, v40, s[68:71], 0 offen
    v_add_u32 v40, 4096, v40
    buffer_load_dword v41, v40, s[68:71], 0 offen
    v_add_u32 v40, 4096, v40
    buffer_load_dword v41, v40, s[68:71], 0 offen
    v_add_u32 v40, 4096, v40
    buffer_load_dword v41, v40, s[68:71], 0 offen
    v_add_u32 v40, 4096, v40
    buffer_load_dword v41, v40, s[68:71], 0 offen
    v_add_u32 v40, 4096, v40
    buffer_load_dword v41, v40, s[68:71], 0 offen
    v_add_u32 v40, 4096, v40
    buffer_load_dword v41, v40, s[68:71], 0 offen
code_pf_done:
    s_mov_b32 s4, s42
    s_mov_b32 s5, s43
    s_and_b32 s5, s5, 0xffff
    s_mov_b32 s6, 0x180000
    s_mov_b32 s7, 0x00020000
    v_lshrrev_b32 v12, 3, v1
    v_and_b32 v13, 7, v1
    v_bfe_u32 v14, v1, 4, 1
    v_and_b32 v15, 1, v2
    v_lshl_or_b32 v14, v15, 1, v14
    v_lshlrev_b32 v14, 1, v14
    v_xor_b32 v14, v13, v14
    v_lshlrev_b32 v14, 4, v14
    v_lshl_add_u32 v16, v2, 3, v12
    v_bfe_u32 v17, v16, 1, 3
    v_xor_b32 v17, v13, v17
    v_lshlrev_b32 v17, 4, v17
    s_lshl_b32 s26, s36, 7
    s_movk_i32 s27, 3072
    v_mul_lo_u32 v18, v16, s27
    v_add3_u32 v4, v18, v14, s26
    v_lshl_add_u32 v15, v2, 4, v12
    v_add_u32 v15, 0, v15
    v_bfe_u32 v19, v15, 1, 3
    v_xor_b32 v19, v13, v19
    v_lshlrev_b32 v19, 4, v19
    s_sub_u32 s27, s35, 16
    v_add_u32 v18, s27, v15
    v_max_i32 v18, 0, v18
    v_lshl_add_u32 v18, v18, 10, v19
    v_cmp_gt_u32 vcc, 80, v15
    v_mov_b32 v19, 0x7fff0000
    s_nop 0
    v_cndmask_b32 v6, v19, v18, vcc
    v_lshl_add_u32 v15, v2, 4, v12
    v_add_u32 v15, 8, v15
    v_bfe_u32 v19, v15, 1, 3
    v_xor_b32 v19, v13, v19
    v_lshlrev_b32 v19, 4, v19
    s_sub_u32 s27, s35, 16
    v_add_u32 v18, s27, v15
    v_max_i32 v18, 0, v18
    v_lshl_add_u32 v18, v18, 10, v19
    v_cmp_gt_u32 vcc, 80, v15
    v_mov_b32 v19, 0x7fff0000
    s_nop 0
    v_cndmask_b32 v7, v19, v18, vcc
    s_lshl_b32 s22, s25, 10
    s_lshl_b32 s28, s25, 11
    s_add_u32 s28, s28, 24576
    s_bfe_u32 s26, s34, 0x20003
    s_lshl_b32 s26, s26, 1
    s_add_u32 s26, s26, s36
    s_and_b32 s26, s26, 7
    s_mul_i32 s20, s26, 196608
    s_lshl_b32 s21, s26, 7
    s_mov_b32 s29, 0
    s_movk_i32 s26, 3584
    v_mul_lo_u32 v18, v16, s26
    v_add3_u32 v20, v18, v14, s65
    v_lshlrev_b32 v18, 10, v16
    s_lshl_b32 s26, s66, 7
    v_add3_u32 v21, v18, v14, s26
    s_lshl_b32 s26, s36, 7
    v_add3_u32 v22, v18, v14, s26
    v_add_u32 v18, s35, v16
    v_lshlrev_b32 v18, 10, v18
    v_add_u32 v23, v18, v17
    s_lshl_b32 s26, s36, 6
    v_add_u32 v18, s26, v16
    s_movk_i32 s26, 3584
    v_mul_lo_u32 v18, v18, s26
    v_add_u32 v24, v18, v17
    v_lshlrev_b32 v18, 12, v16
    s_lshl_b32 s26, s35, 1
    v_add3_u32 v25, v18, v14, s26
    s_add_u32 s26, s28, s29
    s_add_u32 m0, s26, 0
    s_nop 0
    buffer_load_dwordx4 v6, s[8:11], s21 offen lds
    s_add_u32 s26, s28, s29
    s_add_u32 m0, s26, 1024
    s_nop 0
    buffer_load_dwordx4 v7, s[8:11], s21 offen lds
    s_add_u32 s26, s22, s29
    s_add_u32 m0, s26, 0
    s_nop 0
    buffer_load_dwordx4 v4, s[4:7], s20 offen offset:0 lds
    s_add_u32 s26, s22, s29
    s_add_u32 m0, s26, 7168
    s_nop 0
    buffer_load_dwordx4 v4, s[4:7], s20 offen offset:1024 lds
    s_add_u32 s26, s22, s29
    s_add_u32 m0, s26, 14336
    s_nop 0
    buffer_load_dwordx4 v4, s[4:7], s20 offen offset:2048 lds
    s_add_u32 s20, s20, 196608
    s_add_u32 s21, s21, 128
    s_cmp_ge_u32 s21, 1024
    s_cselect_b32 s20, 0, s20
    s_cselect_b32 s21, 0, s21
    s_add_u32 s29, s29, 40960
    s_cmp_ge_u32 s29, 163840
    s_cselect_b32 s29, 0, s29
    s_add_u32 s26, s28, s29
    s_add_u32 m0, s26, 0
    s_nop 0
    buffer_load_dwordx4 v6, s[8:11], s21 offen lds
    s_add_u32 s26, s28, s29
    s_add_u32 m0, s26, 1024
    s_nop 0
    buffer_load_dwordx4 v7, s[8:11], s21 offen lds
    s_add_u32 s26, s22, s29
    s_add_u32 m0, s26, 0
    s_nop 0
    buffer_load_dwordx4 v4, s[4:7], s20 offen offset:0 lds
    s_add_u32 s26, s22, s29
    s_add_u32 m0, s26, 7168
    s_nop 0
    buffer_load_dwordx4 v4, s[4:7], s20 offen offset:1024 lds
    s_add_u32 s26, s22, s29
    s_add_u32 m0, s26, 14336
    s_nop 0
    buffer_load_dwordx4 v4, s[4:7], s20 offen offset:2048 lds
    s_add_u32 s20, s20, 196608
    s_add_u32 s21, s21, 128
    s_cmp_ge_u32 s21, 1024
    s_cselect_b32 s20, 0, s20
    s_cselect_b32 s21, 0, s21
    s_add_u32 s29, s29, 40960
    s_cmp_ge_u32 s29, 163840
    s_cselect_b32 s29, 0, s29
    s_waitcnt vmcnt(5)
    s_barrier
    s_add_u32 s26, s28, s29
    s_add_u32 m0, s26, 0
    s_nop 0
    buffer_load_dwordx4 v6, s[8:11], s21 offen lds
    s_add_u32 s26, s28, s29
    s_add_u32 m0, s26, 1024
    s_nop 0
    buffer_load_dwordx4 v7, s[8:11], s21 offen lds
    s_add_u32 s26, s22, s29
    s_add_u32 m0, s26, 0
    s_nop 0
    buffer_load_dwordx4 v4, s[4:7], s20 offen offset:0 lds
    s_add_u32 s26, s22, s29
    s_add_u32 m0, s26, 7168
    s_nop 0
    buffer_load_dwordx4 v4, s[4:7], s20 offen offset:1024 lds
    s_add_u32 s26, s22, s29
    s_add_u32 m0, s26, 14336
    s_nop 0
    buffer_load_dwordx4 v4, s[4:7], s20 offen offset:2048 lds
    s_add_u32 s20, s20, 196608
    s_add_u32 s21, s21, 128
    s_cmp_ge_u32 s21, 1024
    s_cselect_b32 s20, 0, s20
    s_cselect_b32 s21, 0, s21
    s_add_u32 s29, s29, 40960
    s_cmp_ge_u32 s29, 163840
    s_cselect_b32 s29, 0, s29
    s_add_u32 s26, s28, s29
    s_add_u32 m0, s26, 0
    s_nop 0
    buffer_load_dwordx4 v6, s[8:11], s21 offen lds
    s_add_u32 s26, s28, s29
    s_add_u32 m0, s26, 1024
    s_nop 0
    buffer_load_dwordx4 v7, s[8:11], s21 offen lds
    s_add_u32 s26, s22, s29
    s_add_u32 m0, s26, 0
    s_nop 0
    buffer_load_dwordx4 v4, s[4:7], s20 offen offset:0 lds
    s_add_u32 s26, s22, s29
    s_add_u32 m0, s26, 7168
    s_nop 0
    buffer_load_dwordx4 v4, s[4:7], s20 offen offset:1024 lds
    s_add_u32 s26, s22, s29
    s_add_u32 m0, s26, 14336
    s_nop 0
    buffer_load_dwordx4 v4, s[4:7], s20 offen offset:2048 lds
    s_add_u32 s20, s20, 196608
    s_add_u32 s21, s21, 128
    s_cmp_ge_u32 s21, 1024
    s_cselect_b32 s20, 0, s20
    s_cselect_b32 s21, 0, s21
    s_add_u32 s29, s29, 40960
    s_cmp_ge_u32 s29, 163840
    s_cselect_b32 s29, 0, s29
    s_waitcnt vmcnt(10)
    s_barrier
    s_mov_b32 s24, 0
P1_ploop2:
    s_add_u32 s26, s28, s29
    s_add_u32 m0, s26, 0
    s_nop 0
    buffer_load_dwordx4 v6, s[8:11], s21 offen lds
    s_add_u32 s26, s28, s29
    s_add_u32 m0, s26, 1024
    s_nop 0
    buffer_load_dwordx4 v7, s[8:11], s21 offen lds
    s_add_u32 s26, s22, s29
    s_add_u32 m0, s26, 0
    s_nop 0
    buffer_load_dwordx4 v4, s[4:7], s20 offen offset:0 lds
    s_add_u32 s26, s22, s29
    s_add_u32 m0, s26, 7168
    s_nop 0
    buffer_load_dwordx4 v4, s[4:7], s20 offen offset:1024 lds
    s_add_u32 s26, s22, s29
    s_add_u32 m0, s26, 14336
    s_nop 0
    buffer_load_dwordx4 v4, s[4:7], s20 offen offset:2048 lds
    s_add_u32 s20, s20, 196608
    s_add_u32 s21, s21, 128
    s_cmp_ge_u32 s21, 1024
    s_cselect_b32 s20, 0, s20
    s_cselect_b32 s21, 0, s21
    s_add_u32 s29, s29, 40960
    s_cmp_ge_u32 s29, 163840
    s_cselect_b32 s29, 0, s29
    s_waitcnt vmcnt(10)
    s_barrier
    s_add_u32 s24, s24, 1
    s_cmp_lt_u32 s24, 4
    s_cbranch_scc1 P1_ploop2
    s_waitcnt vmcnt(5)
    s_barrier
    s_waitcnt vmcnt(0)
    s_barrier
    s_waitcnt vmcnt(0)
    s_barrier
    s_lshl_b32 s22, s25, 10
    s_cmp_ge_u32 s33, 28
    s_cbranch_scc1 P_skip
    v_mov_b32 v32, v20
    v_mov_b32 v34, v21
    s_mov_b32 s4, s48
    s_mov_b32 s5, s49
    s_and_b32 s5, s5, 0xffff
    s_mov_b32 s6, 0x700000
    s_mov_b32 s7, 0x00020000
    s_mov_b32 s8, s62
    s_mov_b32 s9, s63
    s_and_b32 s9, s9, 0xffff
    s_mov_b32 s10, 0x200000
    s_mov_b32 s11, 0x00020000
    s_lshl_b32 s26, s66, 2
    s_bfe_u32 s27, s64, 0x20003
    s_add_u32 s26, s26, s27
    s_mul_i32 s20, s26, 229376
    s_lshl_b32 s21, s26, 16
    s_mov_b32 s38, 229376
    s_mov_b32 s39, 65536
    s_mov_b32 s30, 7340032
    s_add_u32 m0, s22, 0
    s_nop 0
    buffer_load_dwordx4 v32, s[4:7], s20 offen lds
    s_add_u32 m0, s22, 8192
    s_nop 0
    buffer_load_dwordx4 v34, s[8:11], s21 offen lds
    s_add_u32 s20, s20, s38
    s_add_u32 s21, s21, s39
    s_cmp_ge_u32 s20, s30
    s_cselect_b32 s20, 0, s20
    s_cselect_b32 s21, 0, s21
    s_add_u32 s22, s22, 16384
    s_and_b32 s22, s22, 0x1ffff
    s_add_u32 m0, s22, 0
    s_nop 0
    buffer_load_dwordx4 v32, s[4:7], s20 offen lds
    s_add_u32 m0, s22, 8192
    s_nop 0
    buffer_load_dwordx4 v34, s[8:11], s21 offen lds
    s_add_u32 s20, s20, s38
    s_add_u32 s21, s21, s39
    s_cmp_ge_u32 s20, s30
    s_cselect_b32 s20, 0, s20
    s_cselect_b32 s21, 0, s21
    s_add_u32 s22, s22, 16384
    s_and_b32 s22, s22, 0x1ffff
    s_barrier
    s_add_u32 m0, s22, 0
    s_nop 0
    buffer_load_dwordx4 v32, s[4:7], s20 offen lds
    s_add_u32 m0, s22, 8192
    s_nop 0
    buffer_load_dwordx4 v34, s[8:11], s21 offen lds
    s_add_u32 s20, s20, s38
    s_add_u32 s21, s21, s39
    s_cmp_ge_u32 s20, s30
    s_cselect_b32 s20, 0, s20
    s_cselect_b32 s21, 0, s21
    s_add_u32 s22, s22, 16384
    s_and_b32 s22, s22, 0x1ffff
    s_add_u32 m0, s22, 0
    s_nop 0
    buffer_load_dwordx4 v32, s[4:7], s20 offen lds
    s_add_u32 m0, s22, 8192
    s_nop 0
    buffer_load_dwordx4 v34, s[8:11], s21 offen lds
    s_add_u32 s20, s20, s38
    s_add_u32 s21, s21, s39
    s_cmp_ge_u32 s20, s30
    s_cselect_b32 s20, 0, s20
    s_cselect_b32 s21, 0, s21
    s_add_u32 s22, s22, 16384
    s_and_b32 s22, s22, 0x1ffff
    s_add_u32 m0, s22, 0
    s_nop 0
    buffer_load_dwordx4 v32, s[4:7], s20 offen lds
    s_add_u32 m0, s22, 8192
    s_nop 0
    buffer_load_dwordx4 v34, s[8:11], s21 offen lds
    s_add_u32 s20, s20, s38
    s_add_u32 s21, s21, s39
    s_cmp_ge_u32 s20, s30
    s_cselect_b32 s20, 0, s20
    s_cselect_b32 s21, 0, s21
    s_add_u32 s22, s22, 16384
    s_and_b32 s22, s22, 0x1ffff
    s_add_u32 m0, s22, 0
    s_nop 0
    buffer_load_dwordx4 v32, s[4:7], s20 offen lds
    s_add_u32 m0, s22, 8192
    s_nop 0
    buffer_load_dwordx4 v34, s[8:11], s21 offen lds
    s_add_u32 s20, s20, s38
    s_add_u32 s21, s21, s39
    s_cmp_ge_u32 s20, s30
    s_cselect_b32 s20, 0, s20
    s_cselect_b32 s21, 0, s21
    s_add_u32 s22, s22, 16384
    s_and_b32 s22, s22, 0x1ffff
    s_add_u32 m0, s22, 0
    s_nop 0
    buffer_load_dwordx4 v32, s[4:7], s20 offen lds
    s_add_u32 m0, s22, 8192
    s_nop 0
    buffer_load_dwordx4 v34, s[8:11], s21 offen lds
    s_add_u32 s20, s20, s38
    s_add_u32 s21, s21, s39
    s_cmp_ge_u32 s20, s30
    s_cselect_b32 s20, 0, s20
    s_cselect_b32 s21, 0, s21
    s_add_u32 s22, s22, 16384
    s_and_b32 s22, s22, 0x1ffff
    s_waitcnt vmcnt(12)
    s_barrier
    s_mov_b32 s24, 0
PA_ploop1:
    s_add_u32 m0, s22, 0
    s_nop 0
    buffer_load_dwordx4 v32, s[4:7], s20 offen lds
    s_add_u32 m0, s22, 8192
    s_nop 0
    buffer_load_dwordx4 v34, s[8:11], s21 offen lds
    s_add_u32 s20, s20, s38
    s_add_u32 s21, s21, s39
    s_cmp_ge_u32 s20, s30
    s_cselect_b32 s20, 0, s20
    s_cselect_b32 s21, 0, s21
    s_add_u32 s22, s22, 16384
    s_and_b32 s22, s22, 0x1ffff
    s_waitcnt vmcnt(12)
    s_barrier
    s_add_u32 s24, s24, 1
    s_cmp_lt_u32 s24, 25
    s_cbranch_scc1 PA_ploop1
    v_mov_b32 v32, v22
    v_mov_b32 v34, v23
    s_mov_b32 s4, s44
    s_mov_b32 s5, s45
    s_and_b32 s5, s5, 0xffff
    s_mov_b32 s6, 0x80000
    s_mov_b32 s7, 0x00020000
    s_add_u32 s8, s62, 0x200000
    s_addc_u32 s9, s63, 0
    s_and_b32 s9, s9, 0xffff
    s_mov_b32 s10, 0x200000
    s_mov_b32 s11, 0x00020000
    s_lshl_b32 s20, s36, 16
    s_lshl_b32 s21, s36, 7
    s_mov_b32 s38, 65536
    s_movk_i32 s39, 128
    s_mov_b32 s30, 524288
    s_add_u32 m0, s22, 0
    s_nop 0
    buffer_load_dwordx4 v32, s[4:7], s20 offen lds
    s_add_u32 m0, s22, 8192
    s_nop 0
    buffer_load_dwordx4 v34, s[8:11], s21 offen lds
    s_add_u32 s20, s20, s38
    s_add_u32 s21, s21, s39
    s_cmp_ge_u32 s20, s30
    s_cselect_b32 s20, 0, s20
    s_cselect_b32 s21, 0, s21
    s_add_u32 s22, s22, 16384
    s_and_b32 s22, s22, 0x1ffff
    s_waitcnt vmcnt(12)
    s_barrier
    s_mov_b32 s24, 0
PA_ploop27:
    s_add_u32 m0, s22, 0
    s_nop 0
    buffer_load_dwordx4 v32, s[4:7], s20 offen lds
    s_add_u32 m0, s22, 8192
    s_nop 0
    buffer_load_dwordx4 v34, s[8:11], s21 offen lds
    s_add_u32 s20, s20, s38
    s_add_u32 s21, s21, s39
    s_cmp_ge_u32 s20, s30
    s_cselect_b32 s20, 0, s20
    s_cselect_b32 s21, 0, s21
    s_add_u32 s22, s22, 16384
    s_and_b32 s22, s22, 0x1ffff
    s_waitcnt vmcnt(12)
    s_barrier
    s_add_u32 s24, s24, 1
    s_cmp_lt_u32 s24, 7
    s_cbranch_scc1 PA_ploop27
    s_waitcnt vmcnt(10)
    s_barrier
    s_waitcnt vmcnt(8)
    s_barrier
    s_waitcnt vmcnt(6)
    s_barrier
    v_mov_b32 v32, v24
    v_mov_b32 v34, v25
    s_add_u32 s4, s62, 0x400000
    s_addc_u32 s5, s63, 0
    s_and_b32 s5, s5, 0xffff
    s_mov_b32 s6, 0x1c0000
    s_mov_b32 s7, 0x00020000
    s_mov_b32 s8, s52
    s_mov_b32 s9, s53
    s_and_b32 s9, s9, 0xffff
    s_mov_b32 s10, 0x700000
    s_mov_b32 s11, 0x00020000
    s_mul_i32 s26, s36, 3
    s_bfe_u32 s27, s34, 0x20003
    s_add_u32 s26, s26, s27
    s_lshl_b32 s20, s26, 7
    s_lshl_b32 s21, s26, 18
    s_movk_i32 s38, 128
    s_mov_b32 s39, 262144
    s_movk_i32 s30, 3584
    s_add_u32 m0, s22, 0
    s_nop 0
    buffer_load_dwordx4 v32, s[4:7], s20 offen lds
    s_add_u32 m0, s22, 8192
    s_nop 0
    buffer_load_dwordx4 v34, s[8:11], s21 offen lds
    s_add_u32 s20, s20, s38
    s_add_u32 s21, s21, s39
    s_cmp_ge_u32 s20, s30
    s_cselect_b32 s20, 0, s20
    s_cselect_b32 s21, 0, s21
    s_add_u32 s22, s22, 16384
    s_and_b32 s22, s22, 0x1ffff
    s_add_u32 m0, s22, 0
    s_nop 0
    buffer_load_dwordx4 v32, s[4:7], s20 offen lds
    s_add_u32 m0, s22, 8192
    s_nop 0
    buffer_load_dwordx4 v34, s[8:11], s21 offen lds
    s_add_u32 s20, s20, s38
    s_add_u32 s21, s21, s39
    s_cmp_ge_u32 s20, s30
    s_cselect_b32 s20, 0, s20
    s_cselect_b32 s21, 0, s21
    s_add_u32 s22, s22, 16384
    s_and_b32 s22, s22, 0x1ffff
    s_waitcnt vmcnt(8)
    s_barrier
    s_add_u32 m0, s22, 0
    s_nop 0
    buffer_load_dwordx4 v32, s[4:7], s20 offen lds
    s_add_u32 m0, s22, 8192
    s_nop 0
    buffer_load_dwordx4 v34, s[8:11], s21 offen lds
    s_add_u32 s20, s20, s38
    s_add_u32 s21, s21, s39
    s_cmp_ge_u32 s20, s30
    s_cselect_b32 s20, 0, s20
    s_cselect_b32 s21, 0, s21
    s_add_u32 s22, s22, 16384
    s_and_b32 s22, s22, 0x1ffff
    s_add_u32 m0, s22, 0
    s_nop 0
    buffer_load_dwordx4 v32, s[4:7], s20 offen lds
    s_add_u32 m0, s22, 8192
    s_nop 0
    buffer_load_dwordx4 v34, s[8:11], s21 offen lds
    s_add_u32 s20, s20, s38
    s_add_u32 s21, s21, s39
    s_cmp_ge_u32 s20, s30
    s_cselect_b32 s20, 0, s20
    s_cselect_b32 s21, 0, s21
    s_add_u32 s22, s22, 16384
    s_and_b32 s22, s22, 0x1ffff
    s_waitcnt vmcnt(10)
    s_barrier
    s_add_u32 m0, s22, 0
    s_nop 0
    buffer_load_dwordx4 v32, s[4:7], s20 offen lds
    s_add_u32 m0, s22, 8192
    s_nop 0
    buffer_load_dwordx4 v34, s[8:11], s21 offen lds
    s_add_u32 s20, s20, s38
    s_add_u32 s21, s21, s39
    s_cmp_ge_u32 s20, s30
    s_cselect_b32 s20, 0, s20
    s_cselect_b32 s21, 0, s21
    s_add_u32 s22, s22, 16384
    s_and_b32 s22, s22, 0x1ffff
    s_add_u32 m0, s22, 0
    s_nop 0
    buffer_load_dwordx4 v32, s[4:7], s20 offen lds
    s_add_u32 m0, s22, 8192
    s_nop 0
    buffer_load_dwordx4 v34, s[8:11], s21 offen lds
    s_add_u32 s20, s20, s38
    s_add_u32 s21, s21, s39
    s_cmp_ge_u32 s20, s30
    s_cselect_b32 s20, 0, s20
    s_cselect_b32 s21, 0, s21
    s_add_u32 s22, s22, 16384
    s_and_b32 s22, s22, 0x1ffff
    s_waitcnt vmcnt(12)
    s_barrier
    s_mov_b32 s24, 0
PA_ploop40:
    s_add_u32 m0, s22, 0
    s_nop 0
    buffer_load_dwordx4 v32, s[4:7], s20 offen lds
    s_add_u32 m0, s22, 8192
    s_nop 0
    buffer_load_dwordx4 v34, s[8:11], s21 offen lds
    s_add_u32 s20, s20, s38
    s_add_u32 s21, s21, s39
    s_cmp_ge_u32 s20, s30
    s_cselect_b32 s20, 0, s20
    s_cselect_b32 s21, 0, s21
    s_add_u32 s22, s22, 16384
    s_and_b32 s22, s22, 0x1ffff
    s_waitcnt vmcnt(12)
    s_barrier
    s_add_u32 s24, s24, 1
    s_cmp_lt_u32 s24, 22
    s_cbranch_scc1 PA_ploop40
    s_waitcnt vmcnt(10)
    s_barrier
    s_waitcnt vmcnt(8)
    s_barrier
    s_waitcnt vmcnt(6)
    s_barrier
    s_waitcnt vmcnt(4)
    s_barrier
    s_waitcnt vmcnt(2)
    s_barrier
    s_waitcnt vmcnt(0)
    s_barrier
    s_waitcnt vmcnt(0)
    s_barrier
    s_endpgm
P_skip:
    s_barrier
    s_barrier
    s_barrier
    v_mov_b32 v32, v22
    v_mov_b32 v34, v23
    s_mov_b32 s4, s44
    s_mov_b32 s5, s45
    s_and_b32 s5, s5, 0xffff
    s_mov_b32 s6, 0x80000
    s_mov_b32 s7, 0x00020000
    s_add_u32 s8, s62, 0x200000
    s_addc_u32 s9, s63, 0
    s_and_b32 s9, s9, 0xffff
    s_mov_b32 s10, 0x200000
    s_mov_b32 s11, 0x00020000
    s_lshl_b32 s20, s36, 16
    s_lshl_b32 s21, s36, 7
    s_mov_b32 s38, 65536
    s_movk_i32 s39, 128
    s_mov_b32 s30, 524288
    s_add_u32 m0, s22, 0
    s_nop 0
    buffer_load_dwordx4 v32, s[4:7], s20 offen lds
    s_add_u32 m0, s22, 8192
    s_nop 0
    buffer_load_dwordx4 v34, s[8:11], s21 offen lds
    s_add_u32 s20, s20, s38
    s_add_u32 s21, s21, s39
    s_cmp_ge_u32 s20, s30
    s_cselect_b32 s20, 0, s20
    s_cselect_b32 s21, 0, s21
    s_add_u32 s22, s22, 16384
    s_and_b32 s22, s22, 0x1ffff
    s_add_u32 m0, s22, 0
    s_nop 0
    buffer_load_dwordx4 v32, s[4:7], s20 offen lds
    s_add_u32 m0, s22, 8192
    s_nop 0
    buffer_load_dwordx4 v34, s[8:11], s21 offen lds
    s_add_u32 s20, s20, s38
    s_add_u32 s21, s21, s39
    s_cmp_ge_u32 s20, s30
    s_cselect_b32 s20, 0, s20
    s_cselect_b32 s21, 0, s21
    s_add_u32 s22, s22, 16384
    s_and_b32 s22, s22, 0x1ffff
    s_add_u32 m0, s22, 0
    s_nop 0
    buffer_load_dwordx4 v32, s[4:7], s20 offen lds
    s_add_u32 m0, s22, 8192
    s_nop 0
    buffer_load_dwordx4 v34, s[8:11], s21 offen lds
    s_add_u32 s20, s20, s38
    s_add_u32 s21, s21, s39
    s_cmp_ge_u32 s20, s30
    s_cselect_b32 s20, 0, s20
    s_cselect_b32 s21, 0, s21
    s_add_u32 s22, s22, 16384
    s_and_b32 s22, s22, 0x1ffff
    s_add_u32 m0, s22, 0
    s_nop 0
    buffer_load_dwordx4 v32, s[4:7], s20 offen lds
    s_add_u32 m0, s22, 8192
    s_nop 0
    buffer_load_dwordx4 v34, s[8:11], s21 offen lds
    s_add_u32 s20, s20, s38
    s_add_u32 s21, s21, s39
    s_cmp_ge_u32 s20, s30
    s_cselect_b32 s20, 0, s20
    s_cselect_b32 s21, 0, s21
    s_add_u32 s22, s22, 16384
    s_and_b32 s22, s22, 0x1ffff
    s_add_u32 m0, s22, 0
    s_nop 0
    buffer_load_dwordx4 v32, s[4:7], s20 offen lds
    s_add_u32 m0, s22, 8192
    s_nop 0
    buffer_load_dwordx4 v34, s[8:11], s21 offen lds
    s_add_u32 s20, s20, s38
    s_add_u32 s21, s21, s39
    s_cmp_ge_u32 s20, s30
    s_cselect_b32 s20, 0, s20
    s_cselect_b32 s21, 0, s21
    s_add_u32 s22, s22, 16384
    s_and_b32 s22, s22, 0x1ffff
    s_add_u32 m0, s22, 0
    s_nop 0
    buffer_load_dwordx4 v32, s[4:7], s20 offen lds
    s_add_u32 m0, s22, 8192
    s_nop 0
    buffer_load_dwordx4 v34, s[8:11], s21 offen lds
    s_add_u32 s20, s20, s38
    s_add_u32 s21, s21, s39
    s_cmp_ge_u32 s20, s30
    s_cselect_b32 s20, 0, s20
    s_cselect_b32 s21, 0, s21
    s_add_u32 s22, s22, 16384
    s_and_b32 s22, s22, 0x1ffff
    s_add_u32 m0, s22, 0
    s_nop 0
    buffer_load_dwordx4 v32, s[4:7], s20 offen lds
    s_add_u32 m0, s22, 8192
    s_nop 0
    buffer_load_dwordx4 v34, s[8:11], s21 offen lds
    s_add_u32 s20, s20, s38
    s_add_u32 s21, s21, s39
    s_cmp_ge_u32 s20, s30
    s_cselect_b32 s20, 0, s20
    s_cselect_b32 s21, 0, s21
    s_add_u32 s22, s22, 16384
    s_and_b32 s22, s22, 0x1ffff
    s_waitcnt vmcnt(12)
    s_barrier
    s_add_u32 m0, s22, 0
    s_nop 0
    buffer_load_dwordx4 v32, s[4:7], s20 offen lds
    s_add_u32 m0, s22, 8192
    s_nop 0
    buffer_load_dwordx4 v34, s[8:11], s21 offen lds
    s_add_u32 s20, s20, s38
    s_add_u32 s21, s21, s39
    s_cmp_ge_u32 s20, s30
    s_cselect_b32 s20, 0, s20
    s_cselect_b32 s21, 0, s21
    s_add_u32 s22, s22, 16384
    s_and_b32 s22, s22, 0x1ffff
    s_waitcnt vmcnt(12)
    s_barrier
    s_waitcnt vmcnt(10)
    s_barrier
    s_waitcnt vmcnt(8)
    s_barrier
    s_waitcnt vmcnt(6)
    s_barrier
    v_mov_b32 v32, v24
    v_mov_b32 v34, v25
    s_add_u32 s4, s62, 0x400000
    s_addc_u32 s5, s63, 0
    s_and_b32 s5, s5, 0xffff
    s_mov_b32 s6, 0x1c0000
    s_mov_b32 s7, 0x00020000
    s_mov_b32 s8, s52
    s_mov_b32 s9, s53
    s_and_b32 s9, s9, 0xffff
    s_mov_b32 s10, 0x700000
    s_mov_b32 s11, 0x00020000
    s_mul_i32 s26, s36, 3
    s_bfe_u32 s27, s34, 0x20003
    s_add_u32 s26, s26, s27
    s_lshl_b32 s20, s26, 7
    s_lshl_b32 s21, s26, 18
    s_movk_i32 s38, 128
    s_mov_b32 s39, 262144
    s_movk_i32 s30, 3584
    s_add_u32 m0, s22, 0
    s_nop 0
    buffer_load_dwordx4 v32, s[4:7], s20 offen lds
    s_add_u32 m0, s22, 8192
    s_nop 0
    buffer_load_dwordx4 v34, s[8:11], s21 offen lds
    s_add_u32 s20, s20, s38
    s_add_u32 s21, s21, s39
    s_cmp_ge_u32 s20, s30
    s_cselect_b32 s20, 0, s20
    s_cselect_b32 s21, 0, s21
    s_add_u32 s22, s22, 16384
    s_and_b32 s22, s22, 0x1ffff
    s_add_u32 m0, s22, 0
    s_nop 0
    buffer_load_dwordx4 v32, s[4:7], s20 offen lds
    s_add_u32 m0, s22, 8192
    s_nop 0
    buffer_load_dwordx4 v34, s[8:11], s21 offen lds
    s_add_u32 s20, s20, s38
    s_add_u32 s21, s21, s39
    s_cmp_ge_u32 s20, s30
    s_cselect_b32 s20, 0, s20
    s_cselect_b32 s21, 0, s21
    s_add_u32 s22, s22, 16384
    s_and_b32 s22, s22, 0x1ffff
    s_waitcnt vmcnt(8)
    s_barrier
    s_add_u32 m0, s22, 0
    s_nop 0
    buffer_load_dwordx4 v32, s[4:7], s20 offen lds
    s_add_u32 m0, s22, 8192
    s_nop 0
    buffer_load_dwordx4 v34, s[8:11], s21 offen lds
    s_add_u32 s20, s20, s38
    s_add_u32 s21, s21, s39
    s_cmp_ge_u32 s20, s30
    s_cselect_b32 s20, 0, s20
    s_cselect_b32 s21, 0, s21
    s_add_u32 s22, s22, 16384
    s_and_b32 s22, s22, 0x1ffff
    s_add_u32 m0, s22, 0
    s_nop 0
    buffer_load_dwordx4 v32, s[4:7], s20 offen lds
    s_add_u32 m0, s22, 8192
    s_nop 0
    buffer_load_dwordx4 v34, s[8:11], s21 offen lds
    s_add_u32 s20, s20, s38
    s_add_u32 s21, s21, s39
    s_cmp_ge_u32 s20, s30
    s_cselect_b32 s20, 0, s20
    s_cselect_b32 s21, 0, s21
    s_add_u32 s22, s22, 16384
    s_and_b32 s22, s22, 0x1ffff
    s_waitcnt vmcnt(10)
    s_barrier
    s_add_u32 m0, s22, 0
    s_nop 0
    buffer_load_dwordx4 v32, s[4:7], s20 offen lds
    s_add_u32 m0, s22, 8192
    s_nop 0
    buffer_load_dwordx4 v34, s[8:11], s21 offen lds
    s_add_u32 s20, s20, s38
    s_add_u32 s21, s21, s39
    s_cmp_ge_u32 s20, s30
    s_cselect_b32 s20, 0, s20
    s_cselect_b32 s21, 0, s21
    s_add_u32 s22, s22, 16384
    s_and_b32 s22, s22, 0x1ffff
    s_add_u32 m0, s22, 0
    s_nop 0
    buffer_load_dwordx4 v32, s[4:7], s20 offen lds
    s_add_u32 m0, s22, 8192
    s_nop 0
    buffer_load_dwordx4 v34, s[8:11], s21 offen lds
    s_add_u32 s20, s20, s38
    s_add_u32 s21, s21, s39
    s_cmp_ge_u32 s20, s30
    s_cselect_b32 s20, 0, s20
    s_cselect_b32 s21, 0, s21
    s_add_u32 s22, s22, 16384
    s_and_b32 s22, s22, 0x1ffff
    s_waitcnt vmcnt(12)
    s_barrier
    s_mov_b32 s24, 0
PB_ploop8:
    s_add_u32 m0, s22, 0
    s_nop 0
    buffer_load_dwordx4 v32, s[4:7], s20 offen lds
    s_add_u32 m0, s22, 8192
    s_nop 0
    buffer_load_dwordx4 v34, s[8:11], s21 offen lds
    s_add_u32 s20, s20, s38
    s_add_u32 s21, s21, s39
    s_cmp_ge_u32 s20, s30
    s_cselect_b32 s20, 0, s20
    s_cselect_b32 s21, 0, s21
    s_add_u32 s22, s22, 16384
    s_and_b32 s22, s22, 0x1ffff
    s_waitcnt vmcnt(12)
    s_barrier
    s_add_u32 s24, s24, 1
    s_cmp_lt_u32 s24, 22
    s_cbranch_scc1 PB_ploop8
    s_waitcnt vmcnt(10)
    s_barrier
    s_waitcnt vmcnt(8)
    s_barrier
    s_waitcnt vmcnt(6)
    s_barrier
    s_waitcnt vmcnt(4)
    s_barrier
    s_waitcnt vmcnt(2)
    s_barrier
    s_waitcnt vmcnt(0)
    s_barrier
    s_waitcnt vmcnt(0)
    s_barrier
    s_endpgm
L_consumer:
    s_mov_b32 s72, s60
    s_mov_b32 s73, s61
    s_and_b32 s73, s73, 0xffff
    s_mov_b32 s74, 0x100
    s_mov_b32 s75, 0x00020000
    s_add_u32 s92, s62, 0x800000
    s_addc_u32 s93, s63, 0
    s_and_b32 s93, s93, 0xffff
    s_mov_b32 s94, 0x10000
    s_mov_b32 s95, 0x00020000
    s_or_b32 s26, s2, s25
    s_cmp_lg_u32 s26, 0
    s_cbranch_scc1 tag_pub_done
    s_memrealtime s[26:27]
    s_waitcnt lgkmcnt(0)
    s_or_b32 s26, s26, 1
    v_mov_b32 v4, 0
    v_mov_b32 v5, s26
    s_mov_b64 exec, 1
    buffer_store_dword v5, v4, s[72:75], 0 offen sc1
    s_mov_b64 exec, -1
tag_pub_done:
    s_mov_b32 s12, s62
    s_mov_b32 s13, s63
    s_and_b32 s13, s13, 0xffff
    s_mov_b32 s14, 0x200000
    s_mov_b32 s15, 0x00020000
    s_add_u32 s16, s62, 0x200000
    s_addc_u32 s17, s63, 0
    s_and_b32 s17, s17, 0xffff
    s_mov_b32 s18, 0x200000
    s_mov_b32 s19, 0x00020000
    s_add_u32 s76, s62, 0x600000
    s_addc_u32 s77, s63, 0
    s_and_b32 s77, s77, 0xffff
    s_mov_b32 s78, 0x2000
    s_mov_b32 s79, 0x00020000
    s_mov_b32 s80, s56
    s_mov_b32 s81, s57
    s_and_b32 s81, s81, 0xffff
    s_mov_b32 s82, 0x400
    s_mov_b32 s83, 0x00020000
    s_mov_b32 s68, s48
    s_mov_b32 s69, s49
    s_and_b32 s69, s69, 0xffff
    s_mov_b32 s70, 0x700000
    s_mov_b32 s71, 0x00020000
    s_lshl_b32 s26, s34, 3
    s_lshl_b32 s27, s25, 1
    s_add_u32 s26, s26, s27
    s_lshl_b32 s27, s26, 10
    v_lshlrev_b32 v3, 4, v1
    v_add_u32 v98, s27, v3
    buffer_load_dwordx4 v[100:103], v98, s[8:11], 0 offen
    buffer_load_dwordx4 v[104:107], v98, s[8:11], 0 offen offset:1024
    buffer_load_dwordx4 v[108:111], v3, s[80:83], 0 offen
    v_lshrrev_b32 v28, 4, v1
    v_bfe_u32 v29, v1, 2, 2
    v_and_b32 v30, 3, v1
    v_lshrrev_b32 v31, 1, v29
    v_and_b32 v20, 1, v28
    v_lshl_or_b32 v31, v20, 1, v31
    v_xor_b32 v31, v2, v31
    v_lshlrev_b32 v31, 5, v31
    v_lshl_add_u32 v20, v28, 3, v29
    v_lshlrev_b32 v20, 7, v20
    v_add_u32 v20, v20, v31
    v_lshl_add_u32 v20, v30, 3, v20
    v_and_b32 v28, 15, v1
    v_lshrrev_b32 v29, 4, v1
    v_lshrrev_b32 v22, 1, v28
    v_xor_b32 v22, v22, v29
    v_lshlrev_b32 v22, 4, v22
    v_lshl_add_u32 v22, v28, 7, v22
    v_add_u32 v22, 24576, v22
    v_xor_b32 v23, 64, v22
    s_waitcnt vmcnt(0)
    v_lshlrev_b32 v128, 16, v108
    v_and_b32 v129, 0xffff0000, v108
    v_lshlrev_b32 v130, 16, v109
    v_and_b32 v131, 0xffff0000, v109
    v_lshlrev_b32 v132, 16, v110
    v_and_b32 v133, 0xffff0000, v110
    v_lshlrev_b32 v134, 16, v111
    v_and_b32 v135, 0xffff0000, v111
    s_mov_b32 s26, 0x3b000000
    s_mov_b32 s27, 0x3727c5ac
    s_mov_b32 s37, 0xbfb8aa3b
    v_lshlrev_b32 v112, 16, v100
    v_and_b32 v113, 0xffff0000, v100
    v_lshlrev_b32 v114, 16, v101
    v_and_b32 v115, 0xffff0000, v101
    v_lshlrev_b32 v116, 16, v102
    v_and_b32 v117, 0xffff0000, v102
    v_lshlrev_b32 v118, 16, v103
    v_and_b32 v119, 0xffff0000, v103
    v_add_f32 v136, v112, v113
    v_add_f32 v136, v136, v114
    v_add_f32 v136, v136, v115
    v_add_f32 v136, v136, v116
    v_add_f32 v136, v136, v117
    v_add_f32 v136, v136, v118
    v_add_f32 v136, v136, v119
    s_nop 1
    v_add_f32_dpp v136, v136, v136 row_shr:1 row_mask:0xf bank_mask:0xf bound_ctrl:0
    s_nop 1
    v_add_f32_dpp v136, v136, v136 row_shr:2 row_mask:0xf bank_mask:0xf bound_ctrl:0
    s_nop 1
    v_add_f32_dpp v136, v136, v136 row_shr:4 row_mask:0xf bank_mask:0xf bound_ctrl:0
    s_nop 1
    v_add_f32_dpp v136, v136, v136 row_shr:8 row_mask:0xf bank_mask:0xf bound_ctrl:0
    s_nop 1
    v_add_f32_dpp v136, v136, v136 row_bcast:15 row_mask:0xa bank_mask:0xf
    s_nop 1
    v_add_f32_dpp v136, v136, v136 row_bcast:31 row_mask:0xc bank_mask:0xf
    s_nop 1
    v_readlane_b32 s28, v136, 63
    v_mul_f32 v137, v112, v128
    v_mul_f32 v138, v113, v129
    v_cvt_pk_bf16_f32 v137, v137, v138
    v_lshlrev_b32 v138, 16, v137
    v_and_b32 v139, 0xffff0000, v137
    v_add_f32 v140, v138, v139
    v_mul_f32 v137, v114, v130
    v_mul_f32 v138, v115, v131
    v_cvt_pk_bf16_f32 v137, v137, v138
    v_lshlrev_b32 v138, 16, v137
    v_and_b32 v139, 0xffff0000, v137
    v_add_f32 v140, v140, v138
    v_add_f32 v140, v140, v139
    v_mul_f32 v137, v116, v132
    v_mul_f32 v138, v117, v133
    v_cvt_pk_bf16_f32 v137, v137, v138
    v_lshlrev_b32 v138, 16, v137
    v_and_b32 v139, 0xffff0000, v137
    v_add_f32 v140, v140, v138
    v_add_f32 v140, v140, v139
    v_mul_f32 v137, v118, v134
    v_mul_f32 v138, v119, v135
    v_cvt_pk_bf16_f32 v137, v137, v138
    v_lshlrev_b32 v138, 16, v137
    v_and_b32 v139, 0xffff0000, v137
    v_add_f32 v140, v140, v138
    v_add_f32 v140, v140, v139
    s_nop 1
    v_add_f32_dpp v140, v140, v140 row_shr:1 row_mask:0xf bank_mask:0xf bound_ctrl:0
    s_nop 1
    v_add_f32_dpp v140, v140, v140 row_shr:2 row_mask:0xf bank_mask:0xf bound_ctrl:0
    s_nop 1
    v_add_f32_dpp v140, v140, v140 row_shr:4 row_mask:0xf bank_mask:0xf bound_ctrl:0
    s_nop 1
    v_add_f32_dpp v140, v140, v140 row_shr:8 row_mask:0xf bank_mask:0xf bound_ctrl:0
    s_nop 1
    v_add_f32_dpp v140, v140, v140 row_bcast:15 row_mask:0xa bank_mask:0xf
    s_nop 1
    v_add_f32_dpp v140, v140, v140 row_bcast:31 row_mask:0xc bank_mask:0xf
    s_nop 1
    v_readlane_b32 s29, v140, 63
    s_nop 1
    v_mov_b32 v136, s26
    v_mul_f32 v136, s28, v136
    v_mov_b32 v141, 0
    v_sub_f32 v137, v112, v136
    v_fmac_f32 v141, v137, v137
    v_sub_f32 v137, v113, v136
    v_fmac_f32 v141, v137, v137
    v_sub_f32 v137, v114, v136
    v_fmac_f32 v141, v137, v137
    v_sub_f32 v137, v115, v136
    v_fmac_f32 v141, v137, v137
    v_sub_f32 v137, v116, v136
    v_fmac_f32 v141, v137, v137
    v_sub_f32 v137, v117, v136
    v_fmac_f32 v141, v137, v137
    v_sub_f32 v137, v118, v136
    v_fmac_f32 v141, v137, v137
    v_sub_f32 v137, v119, v136
    v_fmac_f32 v141, v137, v137
    s_nop 1
    v_add_f32_dpp v141, v141, v141 row_shr:1 row_mask:0xf bank_mask:0xf bound_ctrl:0
    s_nop 1
    v_add_f32_dpp v141, v141, v141 row_shr:2 row_mask:0xf bank_mask:0xf bound_ctrl:0
    s_nop 1
    v_add_f32_dpp v141, v141, v141 row_shr:4 row_mask:0xf bank_mask:0xf bound_ctrl:0
    s_nop 1
    v_add_f32_dpp v141, v141, v141 row_shr:8 row_mask:0xf bank_mask:0xf bound_ctrl:0
    s_nop 1
    v_add_f32_dpp v141, v141, v141 row_bcast:15 row_mask:0xa bank_mask:0xf
    s_nop 1
    v_add_f32_dpp v141, v141, v141 row_bcast:31 row_mask:0xc bank_mask:0xf
    s_nop 1
    v_readlane_b32 s30, v141, 63
    s_nop 1
    v_mov_b32 v137, s26
    v_mul_f32 v137, s30, v137
    v_cvt_pk_bf16_f32 v137, v137, v136
    v_and_b32 v136, 0xffff0000, v137
    v_lshlrev_b32 v137, 16, v137
    v_add_f32 v137, s27, v137
    v_cvt_pk_bf16_f32 v137, v137, v137
    v_lshlrev_b32 v137, 16, v137
    v_sqrt_f32 v137, v137
    s_nop 0
    v_cvt_pk_bf16_f32 v137, v137, v137
    v_lshlrev_b32 v137, 16, v137
    v_rcp_f32 v137, v137
    s_nop 0
    v_sub_f32 v138, v112, v136
    v_sub_f32 v139, v113, v136
    v_cvt_pk_bf16_f32 v138, v138, v139
    v_lshlrev_b32 v139, 16, v138
    v_and_b32 v140, 0xffff0000, v138
    v_mul_f32 v139, v139, v137
    v_mul_f32 v140, v140, v137
    v_cvt_pk_bf16_f32 v144, v139, v140
    v_sub_f32 v138, v114, v136
    v_sub_f32 v139, v115, v136
    v_cvt_pk_bf16_f32 v138, v138, v139
    v_lshlrev_b32 v139, 16, v138
    v_and_b32 v140, 0xffff0000, v138
    v_mul_f32 v139, v139, v137
    v_mul_f32 v140, v140, v137
    v_cvt_pk_bf16_f32 v145, v139, v140
    v_sub_f32 v138, v116, v136
    v_sub_f32 v139, v117, v136
    v_cvt_pk_bf16_f32 v138, v138, v139
    v_lshlrev_b32 v139, 16, v138
    v_and_b32 v140, 0xffff0000, v138
    v_mul_f32 v139, v139, v137
    v_mul_f32 v140, v140, v137
    v_cvt_pk_bf16_f32 v146, v139, v140
    v_sub_f32 v138, v118, v136
    v_sub_f32 v139, v119, v136
    v_cvt_pk_bf16_f32 v138, v138, v139
    v_lshlrev_b32 v139, 16, v138
    v_and_b32 v140, 0xffff0000, v138
    v_mul_f32 v139, v139, v137
    v_mul_f32 v140, v140, v137
    v_cvt_pk_bf16_f32 v147, v139, v140
    buffer_store_dwordx4 v[144:147], v98, s[12:15], 0 offen offset:0 sc1
    v_mov_b32 v138, s29
    v_cvt_pk_bf16_f32 v138, v138, v138
    v_lshlrev_b32 v138, 16, v138
    v_mul_f32 v138, s37, v138
    v_exp_f32 v138, v138
    s_nop 0
    v_add_f32 v138, 1.0, v138
    v_rcp_f32 v138, v138
    s_nop 0
    v_cvt_pk_bf16_f32 v138, v138, v138
    v_lshlrev_b32 v152, 16, v138
    v_lshrrev_b32 v139, 8, v98
    s_mov_b64 exec, 1
    buffer_store_dword v152, v139, s[76:79], 0 offen offset:0 sc1
    s_mov_b64 exec, -1
    v_lshlrev_b32 v120, 16, v104
    v_and_b32 v121, 0xffff0000, v104
    v_lshlrev_b32 v122, 16, v105
    v_and_b32 v123, 0xffff0000, v105
    v_lshlrev_b32 v124, 16, v106
    v_and_b32 v125, 0xffff0000, v106
    v_lshlrev_b32 v126, 16, v107
    v_and_b32 v127, 0xffff0000, v107
    v_add_f32 v136, v120, v121
    v_add_f32 v136, v136, v122
    v_add_f32 v136, v136, v123
    v_add_f32 v136, v136, v124
    v_add_f32 v136, v136, v125
    v_add_f32 v136, v136, v126
    v_add_f32 v136, v136, v127
    s_nop 1
    v_add_f32_dpp v136, v136, v136 row_shr:1 row_mask:0xf bank_mask:0xf bound_ctrl:0
    s_nop 1
    v_add_f32_dpp v136, v136, v136 row_shr:2 row_mask:0xf bank_mask:0xf bound_ctrl:0
    s_nop 1
    v_add_f32_dpp v136, v136, v136 row_shr:4 row_mask:0xf bank_mask:0xf bound_ctrl:0
    s_nop 1
    v_add_f32_dpp v136, v136, v136 row_shr:8 row_mask:0xf bank_mask:0xf bound_ctrl:0
    s_nop 1
    v_add_f32_dpp v136, v136, v136 row_bcast:15 row_mask:0xa bank_mask:0xf
    s_nop 1
    v_add_f32_dpp v136, v136, v136 row_bcast:31 row_mask:0xc bank_mask:0xf
    s_nop 1
    v_readlane_b32 s28, v136, 63
    v_mul_f32 v137, v120, v128
    v_mul_f32 v138, v121, v129
    v_cvt_pk_bf16_f32 v137, v137, v138
    v_lshlrev_b32 v138, 16, v137
    v_and_b32 v139, 0xffff0000, v137
    v_add_f32 v140, v138, v139
    v_mul_f32 v137, v122, v130
    v_mul_f32 v138, v123, v131
    v_cvt_pk_bf16_f32 v137, v137, v138
    v_lshlrev_b32 v138, 16, v137
    v_and_b32 v139, 0xffff0000, v137
    v_add_f32 v140, v140, v138
    v_add_f32 v140, v140, v139
    v_mul_f32 v137, v124, v132
    v_mul_f32 v138, v125, v133
    v_cvt_pk_bf16_f32 v137, v137, v138
    v_lshlrev_b32 v138, 16, v137
    v_and_b32 v139, 0xffff0000, v137
    v_add_f32 v140, v140, v138
    v_add_f32 v140, v140, v139
    v_mul_f32 v137, v126, v134
    v_mul_f32 v138, v127, v135
    v_cvt_pk_bf16_f32 v137, v137, v138
    v_lshlrev_b32 v138, 16, v137
    v_and_b32 v139, 0xffff0000, v137
    v_add_f32 v140, v140, v138
    v_add_f32 v140, v140, v139
    s_nop 1
    v_add_f32_dpp v140, v140, v140 row_shr:1 row_mask:0xf bank_mask:0xf bound_ctrl:0
    s_nop 1
    v_add_f32_dpp v140, v140, v140 row_shr:2 row_mask:0xf bank_mask:0xf bound_ctrl:0
    s_nop 1
    v_add_f32_dpp v140, v140, v140 row_shr:4 row_mask:0xf bank_mask:0xf bound_ctrl:0
    s_nop 1
    v_add_f32_dpp v140, v140, v140 row_shr:8 row_mask:0xf bank_mask:0xf bound_ctrl:0
    s_nop 1
    v_add_f32_dpp v140, v140, v140 row_bcast:15 row_mask:0xa bank_mask:0xf
    s_nop 1
    v_add_f32_dpp v140, v140, v140 row_bcast:31 row_mask:0xc bank_mask:0xf
    s_nop 1
    v_readlane_b32 s29, v140, 63
    s_nop 1
    v_mov_b32 v136, s26
    v_mul_f32 v136, s28, v136
    v_mov_b32 v141, 0
    v_sub_f32 v137, v120, v136
    v_fmac_f32 v141, v137, v137
    v_sub_f32 v137, v121, v136
    v_fmac_f32 v141, v137, v137
    v_sub_f32 v137, v122, v136
    v_fmac_f32 v141, v137, v137
    v_sub_f32 v137, v123, v136
    v_fmac_f32 v141, v137, v137
    v_sub_f32 v137, v124, v136
    v_fmac_f32 v141, v137, v137
    v_sub_f32 v137, v125, v136
    v_fmac_f32 v141, v137, v137
    v_sub_f32 v137, v126, v136
    v_fmac_f32 v141, v137, v137
    v_sub_f32 v137, v127, v136
    v_fmac_f32 v141, v137, v137
    s_nop 1
    v_add_f32_dpp v141, v141, v141 row_shr:1 row_mask:0xf bank_mask:0xf bound_ctrl:0
    s_nop 1
    v_add_f32_dpp v141, v141, v141 row_shr:2 row_mask:0xf bank_mask:0xf bound_ctrl:0
    s_nop 1
    v_add_f32_dpp v141, v141, v141 row_shr:4 row_mask:0xf bank_mask:0xf bound_ctrl:0
    s_nop 1
    v_add_f32_dpp v141, v141, v141 row_shr:8 row_mask:0xf bank_mask:0xf bound_ctrl:0
    s_nop 1
    v_add_f32_dpp v141, v141, v141 row_bcast:15 row_mask:0xa bank_mask:0xf
    s_nop 1
    v_add_f32_dpp v141, v141, v141 row_bcast:31 row_mask:0xc bank_mask:0xf
    s_nop 1
    v_readlane_b32 s30, v141, 63
    s_nop 1
    v_mov_b32 v137, s26
    v_mul_f32 v137, s30, v137
    v_cvt_pk_bf16_f32 v137, v137, v136
    v_and_b32 v136, 0xffff0000, v137
    v_lshlrev_b32 v137, 16, v137
    v_add_f32 v137, s27, v137
    v_cvt_pk_bf16_f32 v137, v137, v137
    v_lshlrev_b32 v137, 16, v137
    v_sqrt_f32 v137, v137
    s_nop 0
    v_cvt_pk_bf16_f32 v137, v137, v137
    v_lshlrev_b32 v137, 16, v137
    v_rcp_f32 v137, v137
    s_nop 0
    v_sub_f32 v138, v120, v136
    v_sub_f32 v139, v121, v136
    v_cvt_pk_bf16_f32 v138, v138, v139
    v_lshlrev_b32 v139, 16, v138
    v_and_b32 v140, 0xffff0000, v138
    v_mul_f32 v139, v139, v137
    v_mul_f32 v140, v140, v137
    v_cvt_pk_bf16_f32 v148, v139, v140
    v_sub_f32 v138, v122, v136
    v_sub_f32 v139, v123, v136
    v_cvt_pk_bf16_f32 v138, v138, v139
    v_lshlrev_b32 v139, 16, v138
    v_and_b32 v140, 0xffff0000, v138
    v_mul_f32 v139, v139, v137
    v_mul_f32 v140, v140, v137
    v_cvt_pk_bf16_f32 v149, v139, v140
    v_sub_f32 v138, v124, v136
    v_sub_f32 v139, v125, v136
    v_cvt_pk_bf16_f32 v138, v138, v139
    v_lshlrev_b32 v139, 16, v138
    v_and_b32 v140, 0xffff0000, v138
    v_mul_f32 v139, v139, v137
    v_mul_f32 v140, v140, v137
    v_cvt_pk_bf16_f32 v150, v139, v140
    v_sub_f32 v138, v126, v136
    v_sub_f32 v139, v127, v136
    v_cvt_pk_bf16_f32 v138, v138, v139
    v_lshlrev_b32 v139, 16, v138
    v_and_b32 v140, 0xffff0000, v138
    v_mul_f32 v139, v139, v137
    v_mul_f32 v140, v140, v137
    v_cvt_pk_bf16_f32 v151, v139, v140
    buffer_store_dwordx4 v[148:151], v98, s[12:15], 0 offen offset:1024 sc1
    v_mov_b32 v138, s29
    v_cvt_pk_bf16_f32 v138, v138, v138
    v_lshlrev_b32 v138, 16, v138
    v_mul_f32 v138, s37, v138
    v_exp_f32 v138, v138
    s_nop 0
    v_add_f32 v138, 1.0, v138
    v_rcp_f32 v138, v138
    s_nop 0
    v_cvt_pk_bf16_f32 v138, v138, v138
    v_lshlrev_b32 v153, 16, v138
    v_lshrrev_b32 v139, 8, v98
    s_mov_b64 exec, 1
    buffer_store_dword v153, v139, s[76:79], 0 offen offset:4 sc1
    s_mov_b64 exec, -1
    v_mov_b32 v100, 0
    v_mov_b32 v101, 0
    v_mov_b32 v102, 0
    v_mov_b32 v103, 0
    v_mov_b32 v104, 0
    v_mov_b32 v105, 0
    v_mov_b32 v106, 0
    v_mov_b32 v107, 0
    v_mov_b32 v108, 0
    v_mov_b32 v109, 0
    v_mov_b32 v110, 0
    v_mov_b32 v111, 0
    v_mov_b32 v112, 0
    v_mov_b32 v113, 0
    v_mov_b32 v114, 0
    v_mov_b32 v115, 0
    v_mov_b32 v116, 0
    v_mov_b32 v117, 0
    v_mov_b32 v118, 0
    v_mov_b32 v119, 0
    v_mov_b32 v120, 0
    v_mov_b32 v121, 0
    v_mov_b32 v122, 0
    v_mov_b32 v123, 0
    v_mov_b32 v124, 0
    v_mov_b32 v125, 0
    v_mov_b32 v126, 0
    v_mov_b32 v127, 0
    v_mov_b32 v128, 0
    v_mov_b32 v129, 0
    v_mov_b32 v130, 0
    v_mov_b32 v131, 0
    v_mov_b32 v132, 0
    v_mov_b32 v133, 0
    v_mov_b32 v134, 0
    v_mov_b32 v135, 0
    v_mov_b32 v136, 0
    v_mov_b32 v137, 0
    v_mov_b32 v138, 0
    v_mov_b32 v139, 0
    v_mov_b32 v140, 0
    v_mov_b32 v141, 0
    v_mov_b32 v142, 0
    v_mov_b32 v143, 0
    v_mov_b32 v144, 0
    v_mov_b32 v145, 0
    v_mov_b32 v146, 0
    v_mov_b32 v147, 0
    v_mov_b32 v148, 0
    v_mov_b32 v149, 0
    v_mov_b32 v150, 0
    v_mov_b32 v151, 0
    v_mov_b32 v152, 0
    v_mov_b32 v153, 0
    v_mov_b32 v154, 0
    v_mov_b32 v155, 0
    s_mov_b32 s23, 0
    s_barrier
    v_add_u32 v24, s23, v20
    v_add_u32 v25, s23, v22
    v_add_u32 v26, s23, v23
    s_add_u32 s23, s23, 40960
    s_cmp_ge_u32 s23, 163840
    s_cselect_b32 s23, 0, s23
    ds_read_b64_tr_b16 v[32:33], v24 offset:0
    ds_read_b64_tr_b16 v[34:35], v24 offset:512
    ds_read_b64_tr_b16 v[36:37], v24 offset:8192
    ds_read_b64_tr_b16 v[38:39], v24 offset:8704
    ds_read_b64_tr_b16 v[40:41], v24 offset:16384
    ds_read_b64_tr_b16 v[42:43], v24 offset:16896
    ds_read_b128 v[44:47], v25 offset:0
    ds_read_b128 v[48:51], v25 offset:2048
    ds_read_b128 v[52:55], v25 offset:4096
    ds_read_b128 v[56:59], v25 offset:6144
    ds_read_b128 v[60:63], v25 offset:8192
    s_waitcnt lgkmcnt(0)
    ds_read_b64_tr_b16 v[64:65], v24 offset:4096
    v_mfma_f32_16x16x32_bf16 v[116:119], v[36:39], v[44:47], v[116:119]
    ds_read_b64_tr_b16 v[66:67], v24 offset:4608
    v_mfma_f32_16x16x32_bf16 v[136:139], v[40:43], v[44:47], v[136:139]
    ds_read_b64_tr_b16 v[68:69], v24 offset:12288
    v_mfma_f32_16x16x32_bf16 v[100:103], v[32:35], v[48:51], v[100:103]
    ds_read_b64_tr_b16 v[70:71], v24 offset:12800
    v_mfma_f32_16x16x32_bf16 v[120:123], v[36:39], v[48:51], v[120:123]
    v_mfma_f32_16x16x32_bf16 v[140:143], v[40:43], v[48:51], v[140:143]
    ds_read_b64_tr_b16 v[72:73], v24 offset:20480
    v_mfma_f32_16x16x32_bf16 v[104:107], v[32:35], v[52:55], v[104:107]
    ds_read_b64_tr_b16 v[74:75], v24 offset:20992
    v_mfma_f32_16x16x32_bf16 v[124:127], v[36:39], v[52:55], v[124:127]
    ds_read_b128 v[76:79], v26 offset:0
    v_mfma_f32_16x16x32_bf16 v[144:147], v[40:43], v[52:55], v[144:147]
    ds_read_b128 v[80:83], v26 offset:2048
    v_mfma_f32_16x16x32_bf16 v[108:111], v[32:35], v[56:59], v[108:111]
    v_mfma_f32_16x16x32_bf16 v[128:131], v[36:39], v[56:59], v[128:131]
    ds_read_b128 v[84:87], v26 offset:4096
    v_mfma_f32_16x16x32_bf16 v[148:151], v[40:43], v[56:59], v[148:151]
    ds_read_b128 v[88:91], v26 offset:6144
    v_mfma_f32_16x16x32_bf16 v[112:115], v[32:35], v[60:63], v[112:115]
    ds_read_b128 v[92:95], v26 offset:8192
    v_mfma_f32_16x16x32_bf16 v[132:135], v[36:39], v[60:63], v[132:135]
    v_mfma_f32_16x16x32_bf16 v[152:155], v[40:43], v[60:63], v[152:155]
    s_waitcnt lgkmcnt(0)
    s_waitcnt vmcnt(0)
    s_barrier
    v_add_u32 v24, s23, v20
    v_add_u32 v25, s23, v22
    v_add_u32 v26, s23, v23
    s_add_u32 s23, s23, 40960
    s_cmp_ge_u32 s23, 163840
    s_cselect_b32 s23, 0, s23
    ds_read_b64_tr_b16 v[32:33], v24 offset:0
    v_mfma_f32_16x16x32_bf16 v[116:119], v[68:71], v[76:79], v[116:119]
    ds_read_b64_tr_b16 v[34:35], v24 offset:512
    v_mfma_f32_16x16x32_bf16 v[136:139], v[72:75], v[76:79], v[136:139]
    ds_read_b64_tr_b16 v[36:37], v24 offset:8192
    v_mfma_f32_16x16x32_bf16 v[100:103], v[64:67], v[80:83], v[100:103]
    ds_read_b64_tr_b16 v[38:39], v24 offset:8704
    v_mfma_f32_16x16x32_bf16 v[120:123], v[68:71], v[80:83], v[120:123]
    v_mfma_f32_16x16x32_bf16 v[140:143], v[72:75], v[80:83], v[140:143]
    ds_read_b64_tr_b16 v[40:41], v24 offset:16384
    v_mfma_f32_16x16x32_bf16 v[104:107], v[64:67], v[84:87], v[104:107]
    ds_read_b64_tr_b16 v[42:43], v24 offset:16896
    v_mfma_f32_16x16x32_bf16 v[124:127], v[68:71], v[84:87], v[124:127]
    ds_read_b128 v[44:47], v25 offset:0
    v_mfma_f32_16x16x32_bf16 v[144:147], v[72:75], v[84:87], v[144:147]
    ds_read_b128 v[48:51], v25 offset:2048
    v_mfma_f32_16x16x32_bf16 v[108:111], v[64:67], v[88:91], v[108:111]
    v_mfma_f32_16x16x32_bf16 v[128:131], v[68:71], v[88:91], v[128:131]
    ds_read_b128 v[52:55], v25 offset:4096
    v_mfma_f32_16x16x32_bf16 v[148:151], v[72:75], v[88:91], v[148:151]
    ds_read_b128 v[56:59], v25 offset:6144
    v_mfma_f32_16x16x32_bf16 v[112:115], v[64:67], v[92:95], v[112:115]
    ds_read_b128 v[60:63], v25 offset:8192
    v_mfma_f32_16x16x32_bf16 v[132:135], v[68:71], v[92:95], v[132:135]
    v_mfma_f32_16x16x32_bf16 v[152:155], v[72:75], v[92:95], v[152:155]
    s_waitcnt lgkmcnt(0)
    ds_read_b64_tr_b16 v[64:65], v24 offset:4096
    v_mfma_f32_16x16x32_bf16 v[116:119], v[36:39], v[44:47], v[116:119]
    ds_read_b64_tr_b16 v[66:67], v24 offset:4608
    v_mfma_f32_16x16x32_bf16 v[136:139], v[40:43], v[44:47], v[136:139]
    ds_read_b64_tr_b16 v[68:69], v24 offset:12288
    v_mfma_f32_16x16x32_bf16 v[100:103], v[32:35], v[48:51], v[100:103]
    ds_read_b64_tr_b16 v[70:71], v24 offset:12800
    v_mfma_f32_16x16x32_bf16 v[120:123], v[36:39], v[48:51], v[120:123]
    v_mfma_f32_16x16x32_bf16 v[140:143], v[40:43], v[48:51], v[140:143]
    ds_read_b64_tr_b16 v[72:73], v24 offset:20480
    v_mfma_f32_16x16x32_bf16 v[104:107], v[32:35], v[52:55], v[104:107]
    ds_read_b64_tr_b16 v[74:75], v24 offset:20992
    v_mfma_f32_16x16x32_bf16 v[124:127], v[36:39], v[52:55], v[124:127]
    ds_read_b128 v[76:79], v26 offset:0
    v_mfma_f32_16x16x32_bf16 v[144:147], v[40:43], v[52:55], v[144:147]
    ds_read_b128 v[80:83], v26 offset:2048
    v_mfma_f32_16x16x32_bf16 v[108:111], v[32:35], v[56:59], v[108:111]
    v_mfma_f32_16x16x32_bf16 v[128:131], v[36:39], v[56:59], v[128:131]
    ds_read_b128 v[84:87], v26 offset:4096
    v_mfma_f32_16x16x32_bf16 v[148:151], v[40:43], v[56:59], v[148:151]
    ds_read_b128 v[88:91], v26 offset:6144
    v_mfma_f32_16x16x32_bf16 v[112:115], v[32:35], v[60:63], v[112:115]
    ds_read_b128 v[92:95], v26 offset:8192
    v_mfma_f32_16x16x32_bf16 v[132:135], v[36:39], v[60:63], v[132:135]
    v_mfma_f32_16x16x32_bf16 v[152:155], v[40:43], v[60:63], v[152:155]
    s_waitcnt lgkmcnt(0)
    s_cmp_lg_u32 s25, 0
    s_cbranch_scc1 tag_done0
    v_mov_b32 v4, 0
    s_mov_b32 s90, 0
tag_loop0:
    buffer_load_dword v5, v4, s[72:75], 0 offen sc1
    s_waitcnt vmcnt(0)
    v_readfirstlane_b32 s88, v5
    s_add_u32 s90, s90, 1
    s_cmp_ge_u32 s90, 200000
    s_cbranch_scc1 tag_done0
    s_cmp_lg_u32 s88, 0
    s_cbranch_scc1 tag_done0
    s_sleep 1
    s_branch tag_loop0
tag_done0:
    s_lshl_b32 s89, s34, 6
    s_cmp_lg_u32 s25, 0
    s_cbranch_scc1 flag_done1
    v_mov_b32 v4, s89
    v_mov_b32 v5, s88
    s_mov_b64 exec, 1
    buffer_store_dword v5, v4, s[92:95], 0 offen sc1
    s_mov_b64 exec, -1
flag_done1:
    s_lshl_b32 s26, s33, 2
    s_add_u32 s26, s26, s25
    s_lshl_b32 s26, s26, 4
    v_lshrrev_b32 v161, 3, v1
    v_add_u32 v161, s26, v161
    s_movk_i32 s27, 3584
    v_mul_lo_u32 v161, v161, s27
    v_and_b32 v160, 7, v1
    v_lshl_add_u32 v161, v160, 6, v161
    s_mul_i32 s26, s32, 28
    s_lshr_b32 s26, s26, 3
    s_lshl_b32 s26, s26, 7
    v_add_u32 v161, s26, v161
    v_add_u32 v160, 28672, v161
    buffer_load_dword v162, v161, s[68:71], 0 offen
    buffer_load_dword v162, v160, s[68:71], 0 offen
    s_mov_b32 s24, 0
C1_loop:
    s_barrier
    v_add_u32 v24, s23, v20
    v_add_u32 v25, s23, v22
    v_add_u32 v26, s23, v23
    s_add_u32 s23, s23, 40960
    s_cmp_ge_u32 s23, 163840
    s_cselect_b32 s23, 0, s23
    ds_read_b64_tr_b16 v[32:33], v24 offset:0
    v_mfma_f32_16x16x32_bf16 v[116:119], v[68:71], v[76:79], v[116:119]
    ds_read_b64_tr_b16 v[34:35], v24 offset:512
    v_mfma_f32_16x16x32_bf16 v[136:139], v[72:75], v[76:79], v[136:139]
    ds_read_b64_tr_b16 v[36:37], v24 offset:8192
    v_mfma_f32_16x16x32_bf16 v[100:103], v[64:67], v[80:83], v[100:103]
    ds_read_b64_tr_b16 v[38:39], v24 offset:8704
    v_mfma_f32_16x16x32_bf16 v[120:123], v[68:71], v[80:83], v[120:123]
    v_mfma_f32_16x16x32_bf16 v[140:143], v[72:75], v[80:83], v[140:143]
    ds_read_b64_tr_b16 v[40:41], v24 offset:16384
    v_mfma_f32_16x16x32_bf16 v[104:107], v[64:67], v[84:87], v[104:107]
    ds_read_b64_tr_b16 v[42:43], v24 offset:16896
    v_mfma_f32_16x16x32_bf16 v[124:127], v[68:71], v[84:87], v[124:127]
    ds_read_b128 v[44:47], v25 offset:0
    v_mfma_f32_16x16x32_bf16 v[144:147], v[72:75], v[84:87], v[144:147]
    ds_read_b128 v[48:51], v25 offset:2048
    v_mfma_f32_16x16x32_bf16 v[108:111], v[64:67], v[88:91], v[108:111]
    v_mfma_f32_16x16x32_bf16 v[128:131], v[68:71], v[88:91], v[128:131]
    ds_read_b128 v[52:55], v25 offset:4096
    v_mfma_f32_16x16x32_bf16 v[148:151], v[72:75], v[88:91], v[148:151]
    ds_read_b128 v[56:59], v25 offset:6144
    v_mfma_f32_16x16x32_bf16 v[112:115], v[64:67], v[92:95], v[112:115]
    ds_read_b128 v[60:63], v25 offset:8192
    v_mfma_f32_16x16x32_bf16 v[132:135], v[68:71], v[92:95], v[132:135]
    v_mfma_f32_16x16x32_bf16 v[152:155], v[72:75], v[92:95], v[152:155]
    s_waitcnt lgkmcnt(0)
    ds_read_b64_tr_b16 v[64:65], v24 offset:4096
    v_mfma_f32_16x16x32_bf16 v[116:119], v[36:39], v[44:47], v[116:119]
    ds_read_b64_tr_b16 v[66:67], v24 offset:4608
    v_mfma_f32_16x16x32_bf16 v[136:139], v[40:43], v[44:47], v[136:139]
    ds_read_b64_tr_b16 v[68:69], v24 offset:12288
    v_mfma_f32_16x16x32_bf16 v[100:103], v[32:35], v[48:51], v[100:103]
    ds_read_b64_tr_b16 v[70:71], v24 offset:12800
    v_mfma_f32_16x16x32_bf16 v[120:123], v[36:39], v[48:51], v[120:123]
    v_mfma_f32_16x16x32_bf16 v[140:143], v[40:43], v[48:51], v[140:143]
    ds_read_b64_tr_b16 v[72:73], v24 offset:20480
    v_mfma_f32_16x16x32_bf16 v[104:107], v[32:35], v[52:55], v[104:107]
    ds_read_b64_tr_b16 v[74:75], v24 offset:20992
    v_mfma_f32_16x16x32_bf16 v[124:127], v[36:39], v[52:55], v[124:127]
    ds_read_b128 v[76:79], v26 offset:0
    v_mfma_f32_16x16x32_bf16 v[144:147], v[40:43], v[52:55], v[144:147]
    ds_read_b128 v[80:83], v26 offset:2048
    v_mfma_f32_16x16x32_bf16 v[108:111], v[32:35], v[56:59], v[108:111]
    v_mfma_f32_16x16x32_bf16 v[128:131], v[36:39], v[56:59], v[128:131]
    ds_read_b128 v[84:87], v26 offset:4096
    v_mfma_f32_16x16x32_bf16 v[148:151], v[40:43], v[56:59], v[148:151]
    ds_read_b128 v[88:91], v26 offset:6144
    v_mfma_f32_16x16x32_bf16 v[112:115], v[32:35], v[60:63], v[112:115]
    ds_read_b128 v[92:95], v26 offset:8192
    v_mfma_f32_16x16x32_bf16 v[132:135], v[36:39], v[60:63], v[132:135]
    v_mfma_f32_16x16x32_bf16 v[152:155], v[40:43], v[60:63], v[152:155]
    s_waitcnt lgkmcnt(0)
    s_add_u32 s24, s24, 1
    s_cmp_lt_u32 s24, 4
    s_cbranch_scc1 C1_loop
    v_mov_b32 v4, v1
    v_lshlrev_b32 v4, 6, v4
    v_add_u32 v4, 0, v4
    s_cmp_lg_u32 s25, 0
    s_cbranch_scc1 polli_done2
    buffer_load_dword v6, v4, s[92:95], 0 offen sc1
    v_add_u32 v5, 4096, v4
    buffer_load_dword v7, v5, s[92:95], 0 offen sc1
    v_add_u32 v5, 8192, v4
    buffer_load_dword v8, v5, s[92:95], 0 offen sc1
    v_add_u32 v5, 12288, v4
    buffer_load_dword v9, v5, s[92:95], 0 offen sc1
polli_done2:
    s_barrier
    v_add_u32 v24, s23, v20
    v_add_u32 v25, s23, v22
    v_add_u32 v26, s23, v23
    s_add_u32 s23, s23, 40960
    s_cmp_ge_u32 s23, 163840
    s_cselect_b32 s23, 0, s23
    ds_read_b64_tr_b16 v[32:33], v24 offset:0
    v_mfma_f32_16x16x32_bf16 v[116:119], v[68:71], v[76:79], v[116:119]
    ds_read_b64_tr_b16 v[34:35], v24 offset:512
    v_mfma_f32_16x16x32_bf16 v[136:139], v[72:75], v[76:79], v[136:139]
    ds_read_b64_tr_b16 v[36:37], v24 offset:8192
    v_mfma_f32_16x16x32_bf16 v[100:103], v[64:67], v[80:83], v[100:103]
    ds_read_b64_tr_b16 v[38:39], v24 offset:8704
    v_mfma_f32_16x16x32_bf16 v[120:123], v[68:71], v[80:83], v[120:123]
    v_mfma_f32_16x16x32_bf16 v[140:143], v[72:75], v[80:83], v[140:143]
    ds_read_b64_tr_b16 v[40:41], v24 offset:16384
    v_mfma_f32_16x16x32_bf16 v[104:107], v[64:67], v[84:87], v[104:107]
    ds_read_b64_tr_b16 v[42:43], v24 offset:16896
    v_mfma_f32_16x16x32_bf16 v[124:127], v[68:71], v[84:87], v[124:127]
    ds_read_b128 v[44:47], v25 offset:0
    v_mfma_f32_16x16x32_bf16 v[144:147], v[72:75], v[84:87], v[144:147]
    ds_read_b128 v[48:51], v25 offset:2048
    v_mfma_f32_16x16x32_bf16 v[108:111], v[64:67], v[88:91], v[108:111]
    v_mfma_f32_16x16x32_bf16 v[128:131], v[68:71], v[88:91], v[128:131]
    ds_read_b128 v[52:55], v25 offset:4096
    v_mfma_f32_16x16x32_bf16 v[148:151], v[72:75], v[88:91], v[148:151]
    ds_read_b128 v[56:59], v25 offset:6144
    v_mfma_f32_16x16x32_bf16 v[112:115], v[64:67], v[92:95], v[112:115]
    ds_read_b128 v[60:63], v25 offset:8192
    v_mfma_f32_16x16x32_bf16 v[132:135], v[68:71], v[92:95], v[132:135]
    v_mfma_f32_16x16x32_bf16 v[152:155], v[72:75], v[92:95], v[152:155]
    s_waitcnt lgkmcnt(0)
    ds_read_b64_tr_b16 v[64:65], v24 offset:4096
    v_mfma_f32_16x16x32_bf16 v[116:119], v[36:39], v[44:47], v[116:119]
    ds_read_b64_tr_b16 v[66:67], v24 offset:4608
    v_mfma_f32_16x16x32_bf16 v[136:139], v[40:43], v[44:47], v[136:139]
    ds_read_b64_tr_b16 v[68:69], v24 offset:12288
    v_mfma_f32_16x16x32_bf16 v[100:103], v[32:35], v[48:51], v[100:103]
    ds_read_b64_tr_b16 v[70:71], v24 offset:12800
    v_mfma_f32_16x16x32_bf16 v[120:123], v[36:39], v[48:51], v[120:123]
    v_mfma_f32_16x16x32_bf16 v[140:143], v[40:43], v[48:51], v[140:143]
    ds_read_b64_tr_b16 v[72:73], v24 offset:20480
    v_mfma_f32_16x16x32_bf16 v[104:107], v[32:35], v[52:55], v[104:107]
    ds_read_b64_tr_b16 v[74:75], v24 offset:20992
    v_mfma_f32_16x16x32_bf16 v[124:127], v[36:39], v[52:55], v[124:127]
    ds_read_b128 v[76:79], v26 offset:0
    v_mfma_f32_16x16x32_bf16 v[144:147], v[40:43], v[52:55], v[144:147]
    ds_read_b128 v[80:83], v26 offset:2048
    v_mfma_f32_16x16x32_bf16 v[108:111], v[32:35], v[56:59], v[108:111]
    v_mfma_f32_16x16x32_bf16 v[128:131], v[36:39], v[56:59], v[128:131]
    ds_read_b128 v[84:87], v26 offset:4096
    v_mfma_f32_16x16x32_bf16 v[148:151], v[40:43], v[56:59], v[148:151]
    ds_read_b128 v[88:91], v26 offset:6144
    v_mfma_f32_16x16x32_bf16 v[112:115], v[32:35], v[60:63], v[112:115]
    ds_read_b128 v[92:95], v26 offset:8192
    v_mfma_f32_16x16x32_bf16 v[132:135], v[36:39], v[60:63], v[132:135]
    v_mfma_f32_16x16x32_bf16 v[152:155], v[40:43], v[60:63], v[152:155]
    s_waitcnt lgkmcnt(0)
    s_barrier
    v_add_u32 v24, s23, v20
    v_add_u32 v25, s23, v22
    v_add_u32 v26, s23, v23
    s_add_u32 s23, s23, 40960
    s_cmp_ge_u32 s23, 163840
    s_cselect_b32 s23, 0, s23
    ds_read_b64_tr_b16 v[32:33], v24 offset:0
    v_mfma_f32_16x16x32_bf16 v[116:119], v[68:71], v[76:79], v[116:119]
    ds_read_b64_tr_b16 v[34:35], v24 offset:512
    v_mfma_f32_16x16x32_bf16 v[136:139], v[72:75], v[76:79], v[136:139]
    ds_read_b64_tr_b16 v[36:37], v24 offset:8192
    v_mfma_f32_16x16x32_bf16 v[100:103], v[64:67], v[80:83], v[100:103]
    ds_read_b64_tr_b16 v[38:39], v24 offset:8704
    v_mfma_f32_16x16x32_bf16 v[120:123], v[68:71], v[80:83], v[120:123]
    v_mfma_f32_16x16x32_bf16 v[140:143], v[72:75], v[80:83], v[140:143]
    ds_read_b64_tr_b16 v[40:41], v24 offset:16384
    v_mfma_f32_16x16x32_bf16 v[104:107], v[64:67], v[84:87], v[104:107]
    ds_read_b64_tr_b16 v[42:43], v24 offset:16896
    v_mfma_f32_16x16x32_bf16 v[124:127], v[68:71], v[84:87], v[124:127]
    ds_read_b128 v[44:47], v25 offset:0
    v_mfma_f32_16x16x32_bf16 v[144:147], v[72:75], v[84:87], v[144:147]
    ds_read_b128 v[48:51], v25 offset:2048
    v_mfma_f32_16x16x32_bf16 v[108:111], v[64:67], v[88:91], v[108:111]
    v_mfma_f32_16x16x32_bf16 v[128:131], v[68:71], v[88:91], v[128:131]
    ds_read_b128 v[52:55], v25 offset:4096
    v_mfma_f32_16x16x32_bf16 v[148:151], v[72:75], v[88:91], v[148:151]
    ds_read_b128 v[56:59], v25 offset:6144
    v_mfma_f32_16x16x32_bf16 v[112:115], v[64:67], v[92:95], v[112:115]
    ds_read_b128 v[60:63], v25 offset:8192
    v_mfma_f32_16x16x32_bf16 v[132:135], v[68:71], v[92:95], v[132:135]
    v_mfma_f32_16x16x32_bf16 v[152:155], v[72:75], v[92:95], v[152:155]
    s_waitcnt lgkmcnt(0)
    ds_read_b64_tr_b16 v[64:65], v24 offset:4096
    v_mfma_f32_16x16x32_bf16 v[116:119], v[36:39], v[44:47], v[116:119]
    ds_read_b64_tr_b16 v[66:67], v24 offset:4608
    v_mfma_f32_16x16x32_bf16 v[136:139], v[40:43], v[44:47], v[136:139]
    ds_read_b64_tr_b16 v[68:69], v24 offset:12288
    v_mfma_f32_16x16x32_bf16 v[100:103], v[32:35], v[48:51], v[100:103]
    ds_read_b64_tr_b16 v[70:71], v24 offset:12800
    v_mfma_f32_16x16x32_bf16 v[120:123], v[36:39], v[48:51], v[120:123]
    v_mfma_f32_16x16x32_bf16 v[140:143], v[40:43], v[48:51], v[140:143]
    ds_read_b64_tr_b16 v[72:73], v24 offset:20480
    v_mfma_f32_16x16x32_bf16 v[104:107], v[32:35], v[52:55], v[104:107]
    ds_read_b64_tr_b16 v[74:75], v24 offset:20992
    v_mfma_f32_16x16x32_bf16 v[124:127], v[36:39], v[52:55], v[124:127]
    ds_read_b128 v[76:79], v26 offset:0
    v_mfma_f32_16x16x32_bf16 v[144:147], v[40:43], v[52:55], v[144:147]
    ds_read_b128 v[80:83], v26 offset:2048
    v_mfma_f32_16x16x32_bf16 v[108:111], v[32:35], v[56:59], v[108:111]
    v_mfma_f32_16x16x32_bf16 v[128:131], v[36:39], v[56:59], v[128:131]
    ds_read_b128 v[84:87], v26 offset:4096
    v_mfma_f32_16x16x32_bf16 v[148:151], v[40:43], v[56:59], v[148:151]
    ds_read_b128 v[88:91], v26 offset:6144
    v_mfma_f32_16x16x32_bf16 v[112:115], v[32:35], v[60:63], v[112:115]
    ds_read_b128 v[92:95], v26 offset:8192
    v_mfma_f32_16x16x32_bf16 v[132:135], v[36:39], v[60:63], v[132:135]
    v_mfma_f32_16x16x32_bf16 v[152:155], v[40:43], v[60:63], v[152:155]
    s_waitcnt lgkmcnt(0)
    s_cmp_lg_u32 s25, 0
    s_cbranch_scc1 poll_done3
    s_mov_b32 s90, 0
    s_branch poll_chk3
poll_loop3:
    buffer_load_dword v6, v4, s[92:95], 0 offen sc1
    v_add_u32 v5, 4096, v4
    buffer_load_dword v7, v5, s[92:95], 0 offen sc1
    v_add_u32 v5, 8192, v4
    buffer_load_dword v8, v5, s[92:95], 0 offen sc1
    v_add_u32 v5, 12288, v4
    buffer_load_dword v9, v5, s[92:95], 0 offen sc1
poll_chk3:
    s_waitcnt vmcnt(0)
    v_cmp_ne_u32 vcc, s88, v6
    v_cmp_ne_u32 s[96:97], s88, v7
    s_or_b64 vcc, vcc, s[96:97]
    v_cmp_ne_u32 s[96:97], s88, v8
    s_or_b64 vcc, vcc, s[96:97]
    v_cmp_ne_u32 s[96:97], s88, v9
    s_or_b64 vcc, vcc, s[96:97]
    s_add_u32 s90, s90, 1
    s_cmp_ge_u32 s90, 200000
    s_cbranch_scc1 poll_done3
    s_cmp_eq_u64 vcc, 0
    s_cbranch_scc1 poll_done3
    s_sleep 2
    s_branch poll_loop3
poll_done3:
    s_barrier
    v_mfma_f32_16x16x32_bf16 v[116:119], v[68:71], v[76:79], v[116:119]
    v_mfma_f32_16x16x32_bf16 v[136:139], v[72:75], v[76:79], v[136:139]
    v_mfma_f32_16x16x32_bf16 v[100:103], v[64:67], v[80:83], v[100:103]
    v_mfma_f32_16x16x32_bf16 v[120:123], v[68:71], v[80:83], v[120:123]
    v_mfma_f32_16x16x32_bf16 v[140:143], v[72:75], v[80:83], v[140:143]
    v_mfma_f32_16x16x32_bf16 v[104:107], v[64:67], v[84:87], v[104:107]
    v_mfma_f32_16x16x32_bf16 v[124:127], v[68:71], v[84:87], v[124:127]
    v_mfma_f32_16x16x32_bf16 v[144:147], v[72:75], v[84:87], v[144:147]
    v_mfma_f32_16x16x32_bf16 v[108:111], v[64:67], v[88:91], v[108:111]
    v_mfma_f32_16x16x32_bf16 v[128:131], v[68:71], v[88:91], v[128:131]
    v_mfma_f32_16x16x32_bf16 v[148:151], v[72:75], v[88:91], v[148:151]
    v_mfma_f32_16x16x32_bf16 v[112:115], v[64:67], v[92:95], v[112:115]
    v_mfma_f32_16x16x32_bf16 v[132:135], v[68:71], v[92:95], v[132:135]
    v_mfma_f32_16x16x32_bf16 v[152:155], v[72:75], v[92:95], v[152:155]
    v_and_b32 v3, 15, v1
    v_lshrrev_b32 v9, 4, v1
    v_lshlrev_b32 v10, 4, v3
    v_and_b32 v11, 1, v9
    v_lshl_add_u32 v10, v11, 3, v10
    v_lshl_add_u32 v10, v2, 13, v10
    v_add_u32 v10, 131072, v10
    v_lshrrev_b32 v11, 1, v9
    v_lshl_add_u32 v12, v11, 10, v10
    v_mul_u32_u24 v11, 1280, v11
    v_add_u32 v13, v11, v10
    s_nop 7
    v_cvt_pk_bf16_f32 v16, v100, v101
    v_cvt_pk_bf16_f32 v17, v102, v103
    ds_write_b64 v12, v[16:17] offset:0
    v_cvt_pk_bf16_f32 v14, v104, v105
    v_cvt_pk_bf16_f32 v15, v106, v107
    ds_write_b64 v12, v[14:15] offset:256
    v_cvt_pk_bf16_f32 v16, v108, v109
    v_cvt_pk_bf16_f32 v17, v110, v111
    ds_write_b64 v12, v[16:17] offset:512
    v_cvt_pk_bf16_f32 v14, v112, v113
    v_cvt_pk_bf16_f32 v15, v114, v115
    ds_write_b64 v12, v[14:15] offset:768
    v_cvt_pk_bf16_f32 v16, v116, v117
    v_cvt_pk_bf16_f32 v17, v118, v119
    ds_write_b64 v13, v[16:17] offset:2048
    v_cvt_pk_bf16_f32 v14, v120, v121
    v_cvt_pk_bf16_f32 v15, v122, v123
    ds_write_b64 v13, v[14:15] offset:2304
    v_cvt_pk_bf16_f32 v16, v124, v125
    v_cvt_pk_bf16_f32 v17, v126, v127
    ds_write_b64 v13, v[16:17] offset:2560
    v_cvt_pk_bf16_f32 v14, v128, v129
    v_cvt_pk_bf16_f32 v15, v130, v131
    ds_write_b64 v13, v[14:15] offset:2816
    v_cvt_pk_bf16_f32 v16, v132, v133
    v_cvt_pk_bf16_f32 v17, v134, v135
    ds_write_b64 v13, v[16:17] offset:3072
    v_cvt_pk_bf16_f32 v14, v136, v137
    v_cvt_pk_bf16_f32 v15, v138, v139
    ds_write_b64 v13, v[14:15] offset:4608
    v_cvt_pk_bf16_f32 v16, v140, v141
    v_cvt_pk_bf16_f32 v17, v142, v143
    ds_write_b64 v13, v[16:17] offset:4864
    v_cvt_pk_bf16_f32 v14, v144, v145
    v_cvt_pk_bf16_f32 v15, v146, v147
    ds_write_b64 v13, v[14:15] offset:5120
    v_cvt_pk_bf16_f32 v16, v148, v149
    v_cvt_pk_bf16_f32 v17, v150, v151
    ds_write_b64 v13, v[16:17] offset:5376
    v_cvt_pk_bf16_f32 v14, v152, v153
    v_cvt_pk_bf16_f32 v15, v154, v155
    ds_write_b64 v13, v[14:15] offset:5632
    s_waitcnt lgkmcnt(0)
    s_barrier
    v_lshrrev_b32 v8, 4, v1
    v_and_b32 v9, 15, v1
    v_lshl_add_u32 v9, v2, 4, v9
    v_lshlrev_b32 v10, 4, v9
    v_lshl_add_u32 v10, v8, 13, v10
    v_add_u32 v10, 131072, v10
    v_add_u32 v11, s35, v9
    ds_read_b128 v[16:19], v10 offset:0
    ds_read_b128 v[20:23], v10 offset:1024
    ds_read_b128 v[24:27], v10 offset:2304
    ds_read_b128 v[28:31], v10 offset:3584
    ds_read_b128 v[32:35], v10 offset:2272
    ds_read_b128 v[36:39], v10 offset:3552
    ds_read_b128 v[40:43], v10 offset:2240
    ds_read_b128 v[44:47], v10 offset:3520
    ds_read_b128 v[48:51], v10 offset:2208
    ds_read_b128 v[52:55], v10 offset:3488
    ds_read_b128 v[56:59], v10 offset:2176
    ds_read_b128 v[60:63], v10 offset:3456
    ds_read_b128 v[64:67], v10 offset:2144
    ds_read_b128 v[68:71], v10 offset:3424
    s_waitcnt lgkmcnt(8)
    ds_read_b128 v[72:75], v10 offset:2112
    ds_read_b128 v[76:79], v10 offset:3392
    ds_read_b128 v[80:83], v10 offset:2080
    ds_read_b128 v[84:87], v10 offset:3360
    v_mov_b32 v88, 0
    v_mov_b32 v89, 0
    v_mov_b32 v90, 0
    v_mov_b32 v91, 0
    v_mov_b32 v92, 0
    v_mov_b32 v93, 0
    v_mov_b32 v94, 0
    v_mov_b32 v95, 0
    s_waitcnt lgkmcnt(0)
    v_dot2_f32_bf16 v88, v16, v24, v88
    v_dot2_f32_bf16 v89, v16, v32, v89
    v_dot2_f32_bf16 v90, v16, v40, v90
    v_dot2_f32_bf16 v91, v16, v48, v91
    v_dot2_f32_bf16 v92, v16, v56, v92
    v_dot2_f32_bf16 v93, v16, v64, v93
    v_dot2_f32_bf16 v94, v16, v72, v94
    v_dot2_f32_bf16 v95, v16, v80, v95
    v_dot2_f32_bf16 v88, v17, v25, v88
    v_dot2_f32_bf16 v89, v17, v33, v89
    v_dot2_f32_bf16 v90, v17, v41, v90
    v_dot2_f32_bf16 v91, v17, v49, v91
    v_dot2_f32_bf16 v92, v17, v57, v92
    v_dot2_f32_bf16 v93, v17, v65, v93
    v_dot2_f32_bf16 v94, v17, v73, v94
    v_dot2_f32_bf16 v95, v17, v81, v95
    v_dot2_f32_bf16 v88, v18, v26, v88
    v_dot2_f32_bf16 v89, v18, v34, v89
    v_dot2_f32_bf16 v90, v18, v42, v90
    v_dot2_f32_bf16 v91, v18, v50, v91
    v_dot2_f32_bf16 v92, v18, v58, v92
    v_dot2_f32_bf16 v93, v18, v66, v93
    v_dot2_f32_bf16 v94, v18, v74, v94
    v_dot2_f32_bf16 v95, v18, v82, v95
    v_dot2_f32_bf16 v88, v19, v27, v88
    v_dot2_f32_bf16 v89, v19, v35, v89
    v_dot2_f32_bf16 v90, v19, v43, v90
    v_dot2_f32_bf16 v91, v19, v51, v91
    v_dot2_f32_bf16 v92, v19, v59, v92
    v_dot2_f32_bf16 v93, v19, v67, v93
    v_dot2_f32_bf16 v94, v19, v75, v94
    v_dot2_f32_bf16 v95, v19, v83, v95
    v_dot2_f32_bf16 v88, v20, v28, v88
    v_dot2_f32_bf16 v89, v20, v36, v89
    v_dot2_f32_bf16 v90, v20, v44, v90
    v_dot2_f32_bf16 v91, v20, v52, v91
    v_dot2_f32_bf16 v92, v20, v60, v92
    v_dot2_f32_bf16 v93, v20, v68, v93
    v_dot2_f32_bf16 v94, v20, v76, v94
    v_dot2_f32_bf16 v95, v20, v84, v95
    v_dot2_f32_bf16 v88, v21, v29, v88
    v_dot2_f32_bf16 v89, v21, v37, v89
    v_dot2_f32_bf16 v90, v21, v45, v90
    v_dot2_f32_bf16 v91, v21, v53, v91
    v_dot2_f32_bf16 v92, v21, v61, v92
    v_dot2_f32_bf16 v93, v21, v69, v93
    v_dot2_f32_bf16 v94, v21, v77, v94
    v_dot2_f32_bf16 v95, v21, v85, v95
    v_dot2_f32_bf16 v88, v22, v30, v88
    v_dot2_f32_bf16 v89, v22, v38, v89
    v_dot2_f32_bf16 v90, v22, v46, v90
    v_dot2_f32_bf16 v91, v22, v54, v91
    v_dot2_f32_bf16 v92, v22, v62, v92
    v_dot2_f32_bf16 v93, v22, v70, v93
    v_dot2_f32_bf16 v94, v22, v78, v94
    v_dot2_f32_bf16 v95, v22, v86, v95
    v_dot2_f32_bf16 v88, v23, v31, v88
    v_dot2_f32_bf16 v89, v23, v39, v89
    v_dot2_f32_bf16 v90, v23, v47, v90
    v_dot2_f32_bf16 v91, v23, v55, v91
    v_dot2_f32_bf16 v92, v23, v63, v92
    v_dot2_f32_bf16 v93, v23, v71, v93
    v_dot2_f32_bf16 v94, v23, v79, v94
    v_dot2_f32_bf16 v95, v23, v87, v95
    s_nop 3
    ds_read_b128 v[24:27], v10 offset:4864
    ds_read_b128 v[28:31], v10 offset:6144
    ds_read_b128 v[32:35], v10 offset:4832
    ds_read_b128 v[36:39], v10 offset:6112
    ds_read_b128 v[40:43], v10 offset:4800
    ds_read_b128 v[44:47], v10 offset:6080
    ds_read_b128 v[48:51], v10 offset:4768
    ds_read_b128 v[52:55], v10 offset:6048
    ds_read_b128 v[56:59], v10 offset:4736
    ds_read_b128 v[60:63], v10 offset:6016
    ds_read_b128 v[64:67], v10 offset:4704
    ds_read_b128 v[68:71], v10 offset:5984
    s_waitcnt lgkmcnt(8)
    ds_read_b128 v[72:75], v10 offset:4672
    ds_read_b128 v[76:79], v10 offset:5952
    ds_read_b128 v[80:83], v10 offset:4640
    ds_read_b128 v[84:87], v10 offset:5920
    v_mov_b32 v12, 0xce6e0000
    v_cvt_pk_bf16_f32 v14, v88, v89
    v_lshlrev_b32 v88, 16, v14
    v_and_b32 v89, 0xffff0000, v14
    v_cvt_pk_bf16_f32 v14, v90, v91
    v_lshlrev_b32 v90, 16, v14
    v_and_b32 v91, 0xffff0000, v14
    v_cvt_pk_bf16_f32 v14, v92, v93
    v_lshlrev_b32 v92, 16, v14
    v_and_b32 v93, 0xffff0000, v14
    v_cvt_pk_bf16_f32 v14, v94, v95
    v_lshlrev_b32 v94, 16, v14
    v_and_b32 v95, 0xffff0000, v14
    v_mul_f32 v88, 0x3e800000, v88
    v_mul_f32 v89, 0x3e800000, v89
    v_mul_f32 v90, 0x3e800000, v90
    v_mul_f32 v91, 0x3e800000, v91
    v_mul_f32 v92, 0x3e800000, v92
    v_mul_f32 v93, 0x3e800000, v93
    v_mul_f32 v94, 0x3e800000, v94
    v_mul_f32 v95, 0x3e800000, v95
    v_cmp_le_u32 vcc, 2, v11
    s_nop 1
    v_cndmask_b32 v89, v12, v89, vcc
    v_cmp_le_u32 vcc, 4, v11
    s_nop 1
    v_cndmask_b32 v90, v12, v90, vcc
    v_cmp_le_u32 vcc, 6, v11
    s_nop 1
    v_cndmask_b32 v91, v12, v91, vcc
    v_cmp_le_u32 vcc, 8, v11
    s_nop 1
    v_cndmask_b32 v92, v12, v92, vcc
    v_cmp_le_u32 vcc, 10, v11
    s_nop 1
    v_cndmask_b32 v93, v12, v93, vcc
    v_cmp_le_u32 vcc, 12, v11
    s_nop 1
    v_cndmask_b32 v94, v12, v94, vcc
    v_cmp_le_u32 vcc, 14, v11
    s_nop 1
    v_cndmask_b32 v95, v12, v95, vcc
    v_max3_f32 v13, v88, v89, v90
    v_max3_f32 v13, v13, v91, v92
    v_max3_f32 v13, v13, v93, v94
    v_max_f32 v13, v13, v95
    s_mov_b32 s26, 0x3fb8aa3b
    v_sub_f32 v88, v88, v13
    v_mul_f32 v88, s26, v88
    v_exp_f32 v88, v88
    v_sub_f32 v89, v89, v13
    v_mul_f32 v89, s26, v89
    v_exp_f32 v89, v89
    v_sub_f32 v90, v90, v13
    v_mul_f32 v90, s26, v90
    v_exp_f32 v90, v90
    v_sub_f32 v91, v91, v13
    v_mul_f32 v91, s26, v91
    v_exp_f32 v91, v91
    v_sub_f32 v92, v92, v13
    v_mul_f32 v92, s26, v92
    v_exp_f32 v92, v92
    v_sub_f32 v93, v93, v13
    v_mul_f32 v93, s26, v93
    v_exp_f32 v93, v93
    v_sub_f32 v94, v94, v13
    v_mul_f32 v94, s26, v94
    v_exp_f32 v94, v94
    v_sub_f32 v95, v95, v13
    v_mul_f32 v95, s26, v95
    v_exp_f32 v95, v95
    s_nop 0
    v_add_f32 v13, v88, v89
    v_add_f32 v13, v13, v90
    v_add_f32 v13, v13, v91
    v_add_f32 v13, v13, v92
    v_add_f32 v13, v13, v93
    v_add_f32 v13, v13, v94
    v_add_f32 v13, v13, v95
    v_rcp_f32 v13, v13
    s_nop 0
    v_mul_f32 v88, v88, v13
    v_mul_f32 v89, v89, v13
    v_mul_f32 v90, v90, v13
    v_mul_f32 v91, v91, v13
    v_mul_f32 v92, v92, v13
    v_mul_f32 v93, v93, v13
    v_mul_f32 v94, v94, v13
    v_mul_f32 v95, v95, v13
    v_cvt_pk_bf16_f32 v96, v88, v89
    v_cvt_pk_bf16_f32 v97, v90, v91
    v_cvt_pk_bf16_f32 v98, v92, v93
    v_cvt_pk_bf16_f32 v99, v94, v95
    v_mov_b32 v100, 0
    v_mov_b32 v101, 0
    v_mov_b32 v102, 0
    v_mov_b32 v103, 0
    v_mov_b32 v104, 0
    v_mov_b32 v105, 0
    v_mov_b32 v106, 0
    v_mov_b32 v107, 0
    v_mov_b32 v108, 0
    v_mov_b32 v109, 0
    v_mov_b32 v110, 0
    v_mov_b32 v111, 0
    v_mov_b32 v112, 0
    v_mov_b32 v113, 0
    v_mov_b32 v114, 0
    v_mov_b32 v115, 0
    s_mov_b32 s26, 0x05040100
    s_mov_b32 s27, 0x07060302
    s_waitcnt lgkmcnt(0)
    v_perm_b32 v116, v32, v24, s26
    v_perm_b32 v117, v32, v24, s27
    v_perm_b32 v118, v33, v25, s26
    v_perm_b32 v119, v33, v25, s27
    v_perm_b32 v120, v34, v26, s26
    v_perm_b32 v121, v34, v26, s27
    v_perm_b32 v122, v35, v27, s26
    v_perm_b32 v123, v35, v27, s27
    v_perm_b32 v124, v36, v28, s26
    v_perm_b32 v125, v36, v28, s27
    v_perm_b32 v126, v37, v29, s26
    v_perm_b32 v127, v37, v29, s27
    v_perm_b32 v128, v38, v30, s26
    v_perm_b32 v129, v38, v30, s27
    v_perm_b32 v130, v39, v31, s26
    v_perm_b32 v131, v39, v31, s27
    v_dot2_f32_bf16 v100, v116, v96, v100
    v_dot2_f32_bf16 v101, v117, v96, v101
    v_dot2_f32_bf16 v102, v118, v96, v102
    v_dot2_f32_bf16 v103, v119, v96, v103
    v_dot2_f32_bf16 v104, v120, v96, v104
    v_dot2_f32_bf16 v105, v121, v96, v105
    v_dot2_f32_bf16 v106, v122, v96, v106
    v_dot2_f32_bf16 v107, v123, v96, v107
    v_dot2_f32_bf16 v108, v124, v96, v108
    v_dot2_f32_bf16 v109, v125, v96, v109
    v_dot2_f32_bf16 v110, v126, v96, v110
    v_dot2_f32_bf16 v111, v127, v96, v111
    v_dot2_f32_bf16 v112, v128, v96, v112
    v_dot2_f32_bf16 v113, v129, v96, v113
    v_dot2_f32_bf16 v114, v130, v96, v114
    v_dot2_f32_bf16 v115, v131, v96, v115
    v_perm_b32 v116, v48, v40, s26
    v_perm_b32 v117, v48, v40, s27
    v_perm_b32 v118, v49, v41, s26
    v_perm_b32 v119, v49, v41, s27
    v_perm_b32 v120, v50, v42, s26
    v_perm_b32 v121, v50, v42, s27
    v_perm_b32 v122, v51, v43, s26
    v_perm_b32 v123, v51, v43, s27
    v_perm_b32 v124, v52, v44, s26
    v_perm_b32 v125, v52, v44, s27
    v_perm_b32 v126, v53, v45, s26
    v_perm_b32 v127, v53, v45, s27
    v_perm_b32 v128, v54, v46, s26
    v_perm_b32 v129, v54, v46, s27
    v_perm_b32 v130, v55, v47, s26
    v_perm_b32 v131, v55, v47, s27
    v_dot2_f32_bf16 v100, v116, v97, v100
    v_dot2_f32_bf16 v101, v117, v97, v101
    v_dot2_f32_bf16 v102, v118, v97, v102
    v_dot2_f32_bf16 v103, v119, v97, v103
    v_dot2_f32_bf16 v104, v120, v97, v104
    v_dot2_f32_bf16 v105, v121, v97, v105
    v_dot2_f32_bf16 v106, v122, v97, v106
    v_dot2_f32_bf16 v107, v123, v97, v107
    v_dot2_f32_bf16 v108, v124, v97, v108
    v_dot2_f32_bf16 v109, v125, v97, v109
    v_dot2_f32_bf16 v110, v126, v97, v110
    v_dot2_f32_bf16 v111, v127, v97, v111
    v_dot2_f32_bf16 v112, v128, v97, v112
    v_dot2_f32_bf16 v113, v129, v97, v113
    v_dot2_f32_bf16 v114, v130, v97, v114
    v_dot2_f32_bf16 v115, v131, v97, v115
    v_perm_b32 v116, v64, v56, s26
    v_perm_b32 v117, v64, v56, s27
    v_perm_b32 v118, v65, v57, s26
    v_perm_b32 v119, v65, v57, s27
    v_perm_b32 v120, v66, v58, s26
    v_perm_b32 v121, v66, v58, s27
    v_perm_b32 v122, v67, v59, s26
    v_perm_b32 v123, v67, v59, s27
    v_perm_b32 v124, v68, v60, s26
    v_perm_b32 v125, v68, v60, s27
    v_perm_b32 v126, v69, v61, s26
    v_perm_b32 v127, v69, v61, s27
    v_perm_b32 v128, v70, v62, s26
    v_perm_b32 v129, v70, v62, s27
    v_perm_b32 v130, v71, v63, s26
    v_perm_b32 v131, v71, v63, s27
    v_dot2_f32_bf16 v100, v116, v98, v100
    v_dot2_f32_bf16 v101, v117, v98, v101
    v_dot2_f32_bf16 v102, v118, v98, v102
    v_dot2_f32_bf16 v103, v119, v98, v103
    v_dot2_f32_bf16 v104, v120, v98, v104
    v_dot2_f32_bf16 v105, v121, v98, v105
    v_dot2_f32_bf16 v106, v122, v98, v106
    v_dot2_f32_bf16 v107, v123, v98, v107
    v_dot2_f32_bf16 v108, v124, v98, v108
    v_dot2_f32_bf16 v109, v125, v98, v109
    v_dot2_f32_bf16 v110, v126, v98, v110
    v_dot2_f32_bf16 v111, v127, v98, v111
    v_dot2_f32_bf16 v112, v128, v98, v112
    v_dot2_f32_bf16 v113, v129, v98, v113
    v_dot2_f32_bf16 v114, v130, v98, v114
    v_dot2_f32_bf16 v115, v131, v98, v115
    v_perm_b32 v116, v80, v72, s26
    v_perm_b32 v117, v80, v72, s27
    v_perm_b32 v118, v81, v73, s26
    v_perm_b32 v119, v81, v73, s27
    v_perm_b32 v120, v82, v74, s26
    v_perm_b32 v121, v82, v74, s27
    v_perm_b32 v122, v83, v75, s26
    v_perm_b32 v123, v83, v75, s27
    v_perm_b32 v124, v84, v76, s26
    v_perm_b32 v125, v84, v76, s27
    v_perm_b32 v126, v85, v77, s26
    v_perm_b32 v127, v85, v77, s27
    v_perm_b32 v128, v86, v78, s26
    v_perm_b32 v129, v86, v78, s27
    v_perm_b32 v130, v87, v79, s26
    v_perm_b32 v131, v87, v79, s27
    v_dot2_f32_bf16 v100, v116, v99, v100
    v_dot2_f32_bf16 v101, v117, v99, v101
    v_dot2_f32_bf16 v102, v118, v99, v102
    v_dot2_f32_bf16 v103, v119, v99, v103
    v_dot2_f32_bf16 v104, v120, v99, v104
    v_dot2_f32_bf16 v105, v121, v99, v105
    v_dot2_f32_bf16 v106, v122, v99, v106
    v_dot2_f32_bf16 v107, v123, v99, v107
    v_dot2_f32_bf16 v108, v124, v99, v108
    v_dot2_f32_bf16 v109, v125, v99, v109
    v_dot2_f32_bf16 v110, v126, v99, v110
    v_dot2_f32_bf16 v111, v127, v99, v111
    v_dot2_f32_bf16 v112, v128, v99, v112
    v_dot2_f32_bf16 v113, v129, v99, v113
    v_dot2_f32_bf16 v114, v130, v99, v114
    v_dot2_f32_bf16 v115, v131, v99, v115
    s_nop 3
    v_cvt_pk_bf16_f32 v116, v100, v101
    v_cvt_pk_bf16_f32 v117, v102, v103
    v_cvt_pk_bf16_f32 v118, v104, v105
    v_cvt_pk_bf16_f32 v119, v106, v107
    v_cvt_pk_bf16_f32 v120, v108, v109
    v_cvt_pk_bf16_f32 v121, v110, v111
    v_cvt_pk_bf16_f32 v122, v112, v113
    v_cvt_pk_bf16_f32 v123, v114, v115
    ds_write_b128 v10, v[116:119]
    ds_write_b128 v10, v[120:123] offset:1024
    v_lshrrev_b32 v12, 3, v1
    v_lshl_add_u32 v12, v2, 4, v12
    v_bfe_u32 v13, v1, 1, 2
    v_and_b32 v14, 1, v1
    v_lshlrev_b32 v15, 4, v12
    v_lshl_add_u32 v15, v13, 13, v15
    v_lshl_add_u32 v15, v14, 10, v15
    v_add_u32 v15, 131072, v15
    v_and_b32 v13, 7, v1
    v_lshlrev_b32 v13, 4, v13
    v_add_u32 v12, s35, v12
    v_lshl_add_u32 v12, v12, 10, v13
    s_lshl_b32 s26, s36, 7
    v_add_u32 v12, s26, v12
    v_add_u32 v13, 8192, v12
    s_waitcnt lgkmcnt(0)
    ds_read_b128 v[116:119], v15
    ds_read_b128 v[120:123], v15 offset:128
    s_waitcnt lgkmcnt(0)
    buffer_store_dwordx4 v[116:119], v12, s[16:19], 0 offen sc1
    buffer_store_dwordx4 v[120:123], v13, s[16:19], 0 offen sc1
    s_lshl_b32 s31, s35, 3
    s_add_u32 s31, s31, 16384
    s_add_u32 s89, s89, 16384
    s_add_u32 s12, s62, 0x400000
    s_addc_u32 s13, s63, 0
    s_and_b32 s13, s13, 0xffff
    s_mov_b32 s14, 0x1c0000
    s_mov_b32 s15, 0x00020000
    s_mov_b32 s16, s50
    s_mov_b32 s17, s51
    s_and_b32 s17, s17, 0xffff
    s_mov_b32 s18, 0xe00
    s_mov_b32 s19, 0x00020000
    s_mov_b32 s84, s58
    s_mov_b32 s85, s59
    s_and_b32 s85, s85, 0xffff
    s_mov_b32 s86, 0x200000
    s_mov_b32 s87, 0x00020000
    s_mov_b32 s68, s54
    s_mov_b32 s69, s55
    s_and_b32 s69, s69, 0xffff
    s_mov_b32 s70, 0x1000
    s_mov_b32 s71, 0x00020000
    v_and_b32 v26, 1, v2
    v_lshrrev_b32 v27, 1, v2
    v_lshl_add_u32 v40, v26, 1, 0
    v_lshrrev_b32 v42, 4, v1
    v_bfe_u32 v43, v1, 2, 2
    v_and_b32 v44, 3, v1
    v_lshrrev_b32 v45, 1, v43
    v_and_b32 v28, 1, v42
    v_lshl_or_b32 v45, v28, 1, v45
    v_xor_b32 v45, v40, v45
    v_lshlrev_b32 v45, 5, v45
    v_lshl_add_u32 v28, v42, 3, v43
    v_lshlrev_b32 v28, 7, v28
    v_add_u32 v28, v28, v45
    v_lshl_add_u32 v28, v44, 3, v28
    v_lshl_add_u32 v40, v27, 1, 0
    v_lshrrev_b32 v42, 4, v1
    v_bfe_u32 v43, v1, 2, 2
    v_and_b32 v44, 3, v1
    v_lshrrev_b32 v45, 1, v43
    v_and_b32 v30, 1, v42
    v_lshl_or_b32 v45, v30, 1, v45
    v_xor_b32 v45, v40, v45
    v_lshlrev_b32 v45, 5, v45
    v_lshl_add_u32 v30, v42, 3, v43
    v_lshlrev_b32 v30, 7, v30
    v_add_u32 v30, v30, v45
    v_lshl_add_u32 v30, v44, 3, v30
    v_add_u32 v30, 8192, v30
    v_lshl_add_u32 v40, v26, 1, 1
    v_lshrrev_b32 v42, 4, v1
    v_bfe_u32 v43, v1, 2, 2
    v_and_b32 v44, 3, v1
    v_lshrrev_b32 v45, 1, v43
    v_and_b32 v29, 1, v42
    v_lshl_or_b32 v45, v29, 1, v45
    v_xor_b32 v45, v40, v45
    v_lshlrev_b32 v45, 5, v45
    v_lshl_add_u32 v29, v42, 3, v43
    v_lshlrev_b32 v29, 7, v29
    v_add_u32 v29, v29, v45
    v_lshl_add_u32 v29, v44, 3, v29
    v_lshl_add_u32 v40, v27, 1, 1
    v_lshrrev_b32 v42, 4, v1
    v_bfe_u32 v43, v1, 2, 2
    v_and_b32 v44, 3, v1
    v_lshrrev_b32 v45, 1, v43
    v_and_b32 v31, 1, v42
    v_lshl_or_b32 v45, v31, 1, v45
    v_xor_b32 v45, v40, v45
    v_lshlrev_b32 v45, 5, v45
    v_lshl_add_u32 v31, v42, 3, v43
    v_lshlrev_b32 v31, 7, v31
    v_add_u32 v31, v31, v45
    v_lshl_add_u32 v31, v44, 3, v31
    v_add_u32 v31, 8192, v31
    v_and_b32 v42, 15, v1
    v_lshrrev_b32 v43, 4, v1
    v_lshrrev_b32 v32, 1, v42
    v_xor_b32 v32, v32, v43
    v_lshlrev_b32 v32, 4, v32
    v_lshl_add_u32 v32, v42, 7, v32
    v_lshl_add_u32 v34, v27, 12, v32
    v_add_u32 v34, 8192, v34
    v_lshl_add_u32 v32, v26, 12, v32
    v_xor_b32 v33, 64, v32
    v_xor_b32 v35, 64, v34
    v_mov_b32 v48, 0
    v_mov_b32 v49, 0
    v_mov_b32 v50, 0
    v_mov_b32 v51, 0
    v_mov_b32 v52, 0
    v_mov_b32 v53, 0
    v_mov_b32 v54, 0
    v_mov_b32 v55, 0
    v_mov_b32 v56, 0
    v_mov_b32 v57, 0
    v_mov_b32 v58, 0
    v_mov_b32 v59, 0
    v_mov_b32 v60, 0
    v_mov_b32 v61, 0
    v_mov_b32 v62, 0
    v_mov_b32 v63, 0
    v_mov_b32 v64, 0
    v_mov_b32 v65, 0
    v_mov_b32 v66, 0
    v_mov_b32 v67, 0
    v_mov_b32 v68, 0
    v_mov_b32 v69, 0
    v_mov_b32 v70, 0
    v_mov_b32 v71, 0
    v_mov_b32 v72, 0
    v_mov_b32 v73, 0
    v_mov_b32 v74, 0
    v_mov_b32 v75, 0
    v_mov_b32 v76, 0
    v_mov_b32 v77, 0
    v_mov_b32 v78, 0
    v_mov_b32 v79, 0
    s_mov_b32 s23, 0
    v_and_b32 v12, 15, v1
    v_lshl_add_u32 v12, v27, 5, v12
    v_add_u32 v12, s35, v12
    v_lshlrev_b32 v13, 2, v12
    buffer_load_dword v20, v13, s[76:79], 0 offen
    buffer_load_dword v21, v13, s[76:79], 0 offen offset:64
    v_lshlrev_b32 v13, 1, v12
    buffer_load_ushort v22, v13, s[68:71], 0 offen
    buffer_load_ushort v23, v13, s[68:71], 0 offen offset:32
    v_lshlrev_b32 v24, 10, v12
    v_lshrrev_b32 v13, 4, v1
    v_lshlrev_b32 v13, 3, v13
    v_lshl_add_u32 v13, v26, 6, v13
    s_lshl_b32 s26, s36, 7
    v_add3_u32 v24, v24, v13, s26
    v_add_u32 v25, 16384, v24
    s_cmp_ge_u32 s33, 28
    s_cbranch_scc1 C_skip
    v_add_u32 v9, s65, v13
    buffer_load_dwordx2 v[14:15], v9, s[16:19], 0 offen
    buffer_load_dwordx2 v[16:17], v9, s[16:19], 0 offen offset:32
    s_barrier
    v_add_u32 v36, s23, v28
    v_add_u32 v38, s23, v30
    v_add_u32 v37, s23, v29
    v_add_u32 v39, s23, v31
    s_add_u32 s23, s23, 16384
    s_and_b32 s23, s23, 0x1ffff
    ds_read_b64_tr_b16 v[80:81], v36 offset:0
    ds_read_b64_tr_b16 v[82:83], v36 offset:512
    ds_read_b64_tr_b16 v[84:85], v37 offset:0
    ds_read_b64_tr_b16 v[86:87], v37 offset:512
    ds_read_b64_tr_b16 v[96:97], v38 offset:0
    ds_read_b64_tr_b16 v[98:99], v38 offset:512
    ds_read_b64_tr_b16 v[100:101], v39 offset:0
    ds_read_b64_tr_b16 v[102:103], v39 offset:512
    ds_read_b64_tr_b16 v[88:89], v36 offset:4096
    ds_read_b64_tr_b16 v[90:91], v36 offset:4608
    ds_read_b64_tr_b16 v[92:93], v37 offset:4096
    ds_read_b64_tr_b16 v[94:95], v37 offset:4608
    ds_read_b64_tr_b16 v[104:105], v38 offset:4096
    ds_read_b64_tr_b16 v[106:107], v38 offset:4608
    ds_read_b64_tr_b16 v[108:109], v39 offset:4096
    ds_read_b64_tr_b16 v[110:111], v39 offset:4608
    s_waitcnt lgkmcnt(0)
    s_barrier
    v_add_u32 v36, s23, v28
    v_add_u32 v38, s23, v30
    v_add_u32 v37, s23, v29
    v_add_u32 v39, s23, v31
    s_add_u32 s23, s23, 16384
    s_and_b32 s23, s23, 0x1ffff
    ds_read_b64_tr_b16 v[112:113], v36 offset:0
    ds_read_b64_tr_b16 v[114:115], v36 offset:512
    v_mfma_f32_16x16x32_bf16 v[48:51], v[80:83], v[96:99], v[48:51]
    ds_read_b64_tr_b16 v[116:117], v37 offset:0
    ds_read_b64_tr_b16 v[118:119], v37 offset:512
    v_mfma_f32_16x16x32_bf16 v[52:55], v[80:83], v[100:103], v[52:55]
    ds_read_b64_tr_b16 v[128:129], v38 offset:0
    ds_read_b64_tr_b16 v[130:131], v38 offset:512
    v_mfma_f32_16x16x32_bf16 v[56:59], v[84:87], v[96:99], v[56:59]
    ds_read_b64_tr_b16 v[132:133], v39 offset:0
    ds_read_b64_tr_b16 v[134:135], v39 offset:512
    v_mfma_f32_16x16x32_bf16 v[60:63], v[84:87], v[100:103], v[60:63]
    ds_read_b64_tr_b16 v[120:121], v36 offset:4096
    ds_read_b64_tr_b16 v[122:123], v36 offset:4608
    v_mfma_f32_16x16x32_bf16 v[48:51], v[88:91], v[104:107], v[48:51]
    ds_read_b64_tr_b16 v[124:125], v37 offset:4096
    ds_read_b64_tr_b16 v[126:127], v37 offset:4608
    v_mfma_f32_16x16x32_bf16 v[52:55], v[88:91], v[108:111], v[52:55]
    ds_read_b64_tr_b16 v[136:137], v38 offset:4096
    ds_read_b64_tr_b16 v[138:139], v38 offset:4608
    v_mfma_f32_16x16x32_bf16 v[56:59], v[92:95], v[104:107], v[56:59]
    ds_read_b64_tr_b16 v[140:141], v39 offset:4096
    ds_read_b64_tr_b16 v[142:143], v39 offset:4608
    v_mfma_f32_16x16x32_bf16 v[60:63], v[92:95], v[108:111], v[60:63]
    s_waitcnt lgkmcnt(0)
    s_barrier
    v_add_u32 v36, s23, v28
    v_add_u32 v38, s23, v30
    v_add_u32 v37, s23, v29
    v_add_u32 v39, s23, v31
    s_add_u32 s23, s23, 16384
    s_and_b32 s23, s23, 0x1ffff
    ds_read_b64_tr_b16 v[80:81], v36 offset:0
    ds_read_b64_tr_b16 v[82:83], v36 offset:512
    v_mfma_f32_16x16x32_bf16 v[48:51], v[112:115], v[128:131], v[48:51]
    ds_read_b64_tr_b16 v[84:85], v37 offset:0
    ds_read_b64_tr_b16 v[86:87], v37 offset:512
    v_mfma_f32_16x16x32_bf16 v[52:55], v[112:115], v[132:135], v[52:55]
    ds_read_b64_tr_b16 v[96:97], v38 offset:0
    ds_read_b64_tr_b16 v[98:99], v38 offset:512
    v_mfma_f32_16x16x32_bf16 v[56:59], v[116:119], v[128:131], v[56:59]
    ds_read_b64_tr_b16 v[100:101], v39 offset:0
    ds_read_b64_tr_b16 v[102:103], v39 offset:512
    v_mfma_f32_16x16x32_bf16 v[60:63], v[116:119], v[132:135], v[60:63]
    ds_read_b64_tr_b16 v[88:89], v36 offset:4096
    ds_read_b64_tr_b16 v[90:91], v36 offset:4608
    v_mfma_f32_16x16x32_bf16 v[48:51], v[120:123], v[136:139], v[48:51]
    ds_read_b64_tr_b16 v[92:93], v37 offset:4096
    ds_read_b64_tr_b16 v[94:95], v37 offset:4608
    v_mfma_f32_16x16x32_bf16 v[52:55], v[120:123], v[140:143], v[52:55]
    ds_read_b64_tr_b16 v[104:105], v38 offset:4096
    ds_read_b64_tr_b16 v[106:107], v38 offset:4608
    v_mfma_f32_16x16x32_bf16 v[56:59], v[124:127], v[136:139], v[56:59]
    ds_read_b64_tr_b16 v[108:109], v39 offset:4096
    ds_read_b64_tr_b16 v[110:111], v39 offset:4608
    v_mfma_f32_16x16x32_bf16 v[60:63], v[124:127], v[140:143], v[60:63]
    s_waitcnt lgkmcnt(0)
    s_barrier
    v_add_u32 v36, s23, v28
    v_add_u32 v38, s23, v30
    v_add_u32 v37, s23, v29
    v_add_u32 v39, s23, v31
    s_add_u32 s23, s23, 16384
    s_and_b32 s23, s23, 0x1ffff
    ds_read_b64_tr_b16 v[112:113], v36 offset:0
    ds_read_b64_tr_b16 v[114:115], v36 offset:512
    v_mfma_f32_16x16x32_bf16 v[48:51], v[80:83], v[96:99], v[48:51]
    ds_read_b64_tr_b16 v[116:117], v37 offset:0
    ds_read_b64_tr_b16 v[118:119], v37 offset:512
    v_mfma_f32_16x16x32_bf16 v[52:55], v[80:83], v[100:103], v[52:55]
    ds_read_b64_tr_b16 v[128:129], v38 offset:0
    ds_read_b64_tr_b16 v[130:131], v38 offset:512
    v_mfma_f32_16x16x32_bf16 v[56:59], v[84:87], v[96:99], v[56:59]
    ds_read_b64_tr_b16 v[132:133], v39 offset:0
    ds_read_b64_tr_b16 v[134:135], v39 offset:512
    v_mfma_f32_16x16x32_bf16 v[60:63], v[84:87], v[100:103], v[60:63]
    ds_read_b64_tr_b16 v[120:121], v36 offset:4096
    ds_read_b64_tr_b16 v[122:123], v36 offset:4608
    v_mfma_f32_16x16x32_bf16 v[48:51], v[88:91], v[104:107], v[48:51]
    ds_read_b64_tr_b16 v[124:125], v37 offset:4096
    ds_read_b64_tr_b16 v[126:127], v37 offset:4608
    v_mfma_f32_16x16x32_bf16 v[52:55], v[88:91], v[108:111], v[52:55]
    ds_read_b64_tr_b16 v[136:137], v38 offset:4096
    ds_read_b64_tr_b16 v[138:139], v38 offset:4608
    v_mfma_f32_16x16x32_bf16 v[56:59], v[92:95], v[104:107], v[56:59]
    ds_read_b64_tr_b16 v[140:141], v39 offset:4096
    ds_read_b64_tr_b16 v[142:143], v39 offset:4608
    v_mfma_f32_16x16x32_bf16 v[60:63], v[92:95], v[108:111], v[60:63]
    s_waitcnt lgkmcnt(0)
    s_barrier
    v_add_u32 v36, s23, v28
    v_add_u32 v38, s23, v30
    v_add_u32 v37, s23, v29
    v_add_u32 v39, s23, v31
    s_add_u32 s23, s23, 16384
    s_and_b32 s23, s23, 0x1ffff
    ds_read_b64_tr_b16 v[80:81], v36 offset:0
    ds_read_b64_tr_b16 v[82:83], v36 offset:512
    v_mfma_f32_16x16x32_bf16 v[48:51], v[112:115], v[128:131], v[48:51]
    ds_read_b64_tr_b16 v[84:85], v37 offset:0
    ds_read_b64_tr_b16 v[86:87], v37 offset:512
    v_mfma_f32_16x16x32_bf16 v[52:55], v[112:115], v[132:135], v[52:55]
    ds_read_b64_tr_b16 v[96:97], v38 offset:0
    ds_read_b64_tr_b16 v[98:99], v38 offset:512
    v_mfma_f32_16x16x32_bf16 v[56:59], v[116:119], v[128:131], v[56:59]
    ds_read_b64_tr_b16 v[100:101], v39 offset:0
    ds_read_b64_tr_b16 v[102:103], v39 offset:512
    v_mfma_f32_16x16x32_bf16 v[60:63], v[116:119], v[132:135], v[60:63]
    ds_read_b64_tr_b16 v[88:89], v36 offset:4096
    ds_read_b64_tr_b16 v[90:91], v36 offset:4608
    v_mfma_f32_16x16x32_bf16 v[48:51], v[120:123], v[136:139], v[48:51]
    ds_read_b64_tr_b16 v[92:93], v37 offset:4096
    ds_read_b64_tr_b16 v[94:95], v37 offset:4608
    v_mfma_f32_16x16x32_bf16 v[52:55], v[120:123], v[140:143], v[52:55]
    ds_read_b64_tr_b16 v[104:105], v38 offset:4096
    ds_read_b64_tr_b16 v[106:107], v38 offset:4608
    v_mfma_f32_16x16x32_bf16 v[56:59], v[124:127], v[136:139], v[56:59]
    ds_read_b64_tr_b16 v[108:109], v39 offset:4096
    ds_read_b64_tr_b16 v[110:111], v39 offset:4608
    v_mfma_f32_16x16x32_bf16 v[60:63], v[124:127], v[140:143], v[60:63]
    s_waitcnt lgkmcnt(0)
    s_waitcnt vmcnt(0)
    s_barrier
    v_add_u32 v36, s23, v28
    v_add_u32 v38, s23, v30
    v_add_u32 v37, s23, v29
    v_add_u32 v39, s23, v31
    s_add_u32 s23, s23, 16384
    s_and_b32 s23, s23, 0x1ffff
    ds_read_b64_tr_b16 v[112:113], v36 offset:0
    ds_read_b64_tr_b16 v[114:115], v36 offset:512
    v_mfma_f32_16x16x32_bf16 v[48:51], v[80:83], v[96:99], v[48:51]
    ds_read_b64_tr_b16 v[116:117], v37 offset:0
    ds_read_b64_tr_b16 v[118:119], v37 offset:512
    v_mfma_f32_16x16x32_bf16 v[52:55], v[80:83], v[100:103], v[52:55]
    ds_read_b64_tr_b16 v[128:129], v38 offset:0
    ds_read_b64_tr_b16 v[130:131], v38 offset:512
    v_mfma_f32_16x16x32_bf16 v[56:59], v[84:87], v[96:99], v[56:59]
    ds_read_b64_tr_b16 v[132:133], v39 offset:0
    ds_read_b64_tr_b16 v[134:135], v39 offset:512
    v_mfma_f32_16x16x32_bf16 v[60:63], v[84:87], v[100:103], v[60:63]
    ds_read_b64_tr_b16 v[120:121], v36 offset:4096
    ds_read_b64_tr_b16 v[122:123], v36 offset:4608
    v_mfma_f32_16x16x32_bf16 v[48:51], v[88:91], v[104:107], v[48:51]
    ds_read_b64_tr_b16 v[124:125], v37 offset:4096
    ds_read_b64_tr_b16 v[126:127], v37 offset:4608
    v_mfma_f32_16x16x32_bf16 v[52:55], v[88:91], v[108:111], v[52:55]
    ds_read_b64_tr_b16 v[136:137], v38 offset:4096
    ds_read_b64_tr_b16 v[138:139], v38 offset:4608
    v_mfma_f32_16x16x32_bf16 v[56:59], v[92:95], v[104:107], v[56:59]
    ds_read_b64_tr_b16 v[140:141], v39 offset:4096
    ds_read_b64_tr_b16 v[142:143], v39 offset:4608
    v_mfma_f32_16x16x32_bf16 v[60:63], v[92:95], v[108:111], v[60:63]
    s_waitcnt lgkmcnt(0)
    s_cmp_lg_u32 s25, 0
    s_cbranch_scc1 flag_done4
    v_mov_b32 v4, s89
    v_mov_b32 v5, s88
    s_mov_b64 exec, 1
    buffer_store_dword v5, v4, s[92:95], 0 offen sc1
    s_mov_b64 exec, -1
flag_done4:
    s_barrier
    v_add_u32 v36, s23, v28
    v_add_u32 v38, s23, v30
    v_add_u32 v37, s23, v29
    v_add_u32 v39, s23, v31
    s_add_u32 s23, s23, 16384
    s_and_b32 s23, s23, 0x1ffff
    ds_read_b64_tr_b16 v[80:81], v36 offset:0
    ds_read_b64_tr_b16 v[82:83], v36 offset:512
    v_mfma_f32_16x16x32_bf16 v[48:51], v[112:115], v[128:131], v[48:51]
    ds_read_b64_tr_b16 v[84:85], v37 offset:0
    ds_read_b64_tr_b16 v[86:87], v37 offset:512
    v_mfma_f32_16x16x32_bf16 v[52:55], v[112:115], v[132:135], v[52:55]
    ds_read_b64_tr_b16 v[96:97], v38 offset:0
    ds_read_b64_tr_b16 v[98:99], v38 offset:512
    v_mfma_f32_16x16x32_bf16 v[56:59], v[116:119], v[128:131], v[56:59]
    ds_read_b64_tr_b16 v[100:101], v39 offset:0
    ds_read_b64_tr_b16 v[102:103], v39 offset:512
    v_mfma_f32_16x16x32_bf16 v[60:63], v[116:119], v[132:135], v[60:63]
    ds_read_b64_tr_b16 v[88:89], v36 offset:4096
    ds_read_b64_tr_b16 v[90:91], v36 offset:4608
    v_mfma_f32_16x16x32_bf16 v[48:51], v[120:123], v[136:139], v[48:51]
    ds_read_b64_tr_b16 v[92:93], v37 offset:4096
    ds_read_b64_tr_b16 v[94:95], v37 offset:4608
    v_mfma_f32_16x16x32_bf16 v[52:55], v[120:123], v[140:143], v[52:55]
    ds_read_b64_tr_b16 v[104:105], v38 offset:4096
    ds_read_b64_tr_b16 v[106:107], v38 offset:4608
    v_mfma_f32_16x16x32_bf16 v[56:59], v[124:127], v[136:139], v[56:59]
    ds_read_b64_tr_b16 v[108:109], v39 offset:4096
    ds_read_b64_tr_b16 v[110:111], v39 offset:4608
    v_mfma_f32_16x16x32_bf16 v[60:63], v[124:127], v[140:143], v[60:63]
    s_waitcnt lgkmcnt(0)
    s_barrier
    v_add_u32 v36, s23, v28
    v_add_u32 v38, s23, v30
    v_add_u32 v37, s23, v29
    v_add_u32 v39, s23, v31
    s_add_u32 s23, s23, 16384
    s_and_b32 s23, s23, 0x1ffff
    ds_read_b64_tr_b16 v[112:113], v36 offset:0
    ds_read_b64_tr_b16 v[114:115], v36 offset:512
    v_mfma_f32_16x16x32_bf16 v[48:51], v[80:83], v[96:99], v[48:51]
    ds_read_b64_tr_b16 v[116:117], v37 offset:0
    ds_read_b64_tr_b16 v[118:119], v37 offset:512
    v_mfma_f32_16x16x32_bf16 v[52:55], v[80:83], v[100:103], v[52:55]
    ds_read_b64_tr_b16 v[128:129], v38 offset:0
    ds_read_b64_tr_b16 v[130:131], v38 offset:512
    v_mfma_f32_16x16x32_bf16 v[56:59], v[84:87], v[96:99], v[56:59]
    ds_read_b64_tr_b16 v[132:133], v39 offset:0
    ds_read_b64_tr_b16 v[134:135], v39 offset:512
    v_mfma_f32_16x16x32_bf16 v[60:63], v[84:87], v[100:103], v[60:63]
    ds_read_b64_tr_b16 v[120:121], v36 offset:4096
    ds_read_b64_tr_b16 v[122:123], v36 offset:4608
    v_mfma_f32_16x16x32_bf16 v[48:51], v[88:91], v[104:107], v[48:51]
    ds_read_b64_tr_b16 v[124:125], v37 offset:4096
    ds_read_b64_tr_b16 v[126:127], v37 offset:4608
    v_mfma_f32_16x16x32_bf16 v[52:55], v[88:91], v[108:111], v[52:55]
    ds_read_b64_tr_b16 v[136:137], v38 offset:4096
    ds_read_b64_tr_b16 v[138:139], v38 offset:4608
    v_mfma_f32_16x16x32_bf16 v[56:59], v[92:95], v[104:107], v[56:59]
    ds_read_b64_tr_b16 v[140:141], v39 offset:4096
    ds_read_b64_tr_b16 v[142:143], v39 offset:4608
    v_mfma_f32_16x16x32_bf16 v[60:63], v[92:95], v[108:111], v[60:63]
    s_waitcnt lgkmcnt(0)
    s_barrier
    v_add_u32 v36, s23, v28
    v_add_u32 v38, s23, v30
    v_add_u32 v37, s23, v29
    v_add_u32 v39, s23, v31
    s_add_u32 s23, s23, 16384
    s_and_b32 s23, s23, 0x1ffff
    ds_read_b64_tr_b16 v[80:81], v36 offset:0
    ds_read_b64_tr_b16 v[82:83], v36 offset:512
    v_mfma_f32_16x16x32_bf16 v[48:51], v[112:115], v[128:131], v[48:51]
    ds_read_b64_tr_b16 v[84:85], v37 offset:0
    ds_read_b64_tr_b16 v[86:87], v37 offset:512
    v_mfma_f32_16x16x32_bf16 v[52:55], v[112:115], v[132:135], v[52:55]
    ds_read_b64_tr_b16 v[96:97], v38 offset:0
    ds_read_b64_tr_b16 v[98:99], v38 offset:512
    v_mfma_f32_16x16x32_bf16 v[56:59], v[116:119], v[128:131], v[56:59]
    ds_read_b64_tr_b16 v[100:101], v39 offset:0
    ds_read_b64_tr_b16 v[102:103], v39 offset:512
    v_mfma_f32_16x16x32_bf16 v[60:63], v[116:119], v[132:135], v[60:63]
    ds_read_b64_tr_b16 v[88:89], v36 offset:4096
    ds_read_b64_tr_b16 v[90:91], v36 offset:4608
    v_mfma_f32_16x16x32_bf16 v[48:51], v[120:123], v[136:139], v[48:51]
    ds_read_b64_tr_b16 v[92:93], v37 offset:4096
    ds_read_b64_tr_b16 v[94:95], v37 offset:4608
    v_mfma_f32_16x16x32_bf16 v[52:55], v[120:123], v[140:143], v[52:55]
    ds_read_b64_tr_b16 v[104:105], v38 offset:4096
    ds_read_b64_tr_b16 v[106:107], v38 offset:4608
    v_mfma_f32_16x16x32_bf16 v[56:59], v[124:127], v[136:139], v[56:59]
    ds_read_b64_tr_b16 v[108:109], v39 offset:4096
    ds_read_b64_tr_b16 v[110:111], v39 offset:4608
    v_mfma_f32_16x16x32_bf16 v[60:63], v[124:127], v[140:143], v[60:63]
    s_waitcnt lgkmcnt(0)
    s_mov_b32 s4, s52
    s_mov_b32 s5, s53
    s_and_b32 s5, s5, 0xffff
    s_mov_b32 s6, 0x700000
    s_mov_b32 s7, 0x00020000
    s_mov_b32 s8, s44
    s_mov_b32 s9, s45
    s_and_b32 s9, s9, 0xffff
    s_mov_b32 s10, 0x80000
    s_mov_b32 s11, 0x00020000
    s_lshl_b32 s26, s33, 2
    s_add_u32 s26, s26, s25
    s_lshl_b32 s26, s26, 4
    v_lshrrev_b32 v45, 3, v1
    v_add_u32 v45, s26, v45
    v_lshlrev_b32 v45, 12, v45
    v_and_b32 v46, 7, v1
    v_lshl_add_u32 v45, v46, 6, v45
    s_lshl_b32 s26, s32, 9
    v_add_u32 v45, s26, v45
    buffer_load_dword v47, v45, s[4:7], 0 offen
    s_mul_i32 s26, s64, 2368
    v_lshlrev_b32 v46, 6, v1
    v_add_u32 v46, s26, v46
    buffer_load_dword v47, v46, s[8:11], 0 offen
    s_mov_b32 s24, 0
CG_loop0:
    s_barrier
    v_add_u32 v36, s23, v28
    v_add_u32 v38, s23, v30
    v_add_u32 v37, s23, v29
    v_add_u32 v39, s23, v31
    s_add_u32 s23, s23, 16384
    s_and_b32 s23, s23, 0x1ffff
    ds_read_b64_tr_b16 v[112:113], v36 offset:0
    ds_read_b64_tr_b16 v[114:115], v36 offset:512
    v_mfma_f32_16x16x32_bf16 v[48:51], v[80:83], v[96:99], v[48:51]
    ds_read_b64_tr_b16 v[116:117], v37 offset:0
    ds_read_b64_tr_b16 v[118:119], v37 offset:512
    v_mfma_f32_16x16x32_bf16 v[52:55], v[80:83], v[100:103], v[52:55]
    ds_read_b64_tr_b16 v[128:129], v38 offset:0
    ds_read_b64_tr_b16 v[130:131], v38 offset:512
    v_mfma_f32_16x16x32_bf16 v[56:59], v[84:87], v[96:99], v[56:59]
    ds_read_b64_tr_b16 v[132:133], v39 offset:0
    ds_read_b64_tr_b16 v[134:135], v39 offset:512
    v_mfma_f32_16x16x32_bf16 v[60:63], v[84:87], v[100:103], v[60:63]
    ds_read_b64_tr_b16 v[120:121], v36 offset:4096
    ds_read_b64_tr_b16 v[122:123], v36 offset:4608
    v_mfma_f32_16x16x32_bf16 v[48:51], v[88:91], v[104:107], v[48:51]
    ds_read_b64_tr_b16 v[124:125], v37 offset:4096
    ds_read_b64_tr_b16 v[126:127], v37 offset:4608
    v_mfma_f32_16x16x32_bf16 v[52:55], v[88:91], v[108:111], v[52:55]
    ds_read_b64_tr_b16 v[136:137], v38 offset:4096
    ds_read_b64_tr_b16 v[138:139], v38 offset:4608
    v_mfma_f32_16x16x32_bf16 v[56:59], v[92:95], v[104:107], v[56:59]
    ds_read_b64_tr_b16 v[140:141], v39 offset:4096
    ds_read_b64_tr_b16 v[142:143], v39 offset:4608
    v_mfma_f32_16x16x32_bf16 v[60:63], v[92:95], v[108:111], v[60:63]
    s_waitcnt lgkmcnt(0)
    s_barrier
    v_add_u32 v36, s23, v28
    v_add_u32 v38, s23, v30
    v_add_u32 v37, s23, v29
    v_add_u32 v39, s23, v31
    s_add_u32 s23, s23, 16384
    s_and_b32 s23, s23, 0x1ffff
    ds_read_b64_tr_b16 v[80:81], v36 offset:0
    ds_read_b64_tr_b16 v[82:83], v36 offset:512
    v_mfma_f32_16x16x32_bf16 v[48:51], v[112:115], v[128:131], v[48:51]
    ds_read_b64_tr_b16 v[84:85], v37 offset:0
    ds_read_b64_tr_b16 v[86:87], v37 offset:512
    v_mfma_f32_16x16x32_bf16 v[52:55], v[112:115], v[132:135], v[52:55]
    ds_read_b64_tr_b16 v[96:97], v38 offset:0
    ds_read_b64_tr_b16 v[98:99], v38 offset:512
    v_mfma_f32_16x16x32_bf16 v[56:59], v[116:119], v[128:131], v[56:59]
    ds_read_b64_tr_b16 v[100:101], v39 offset:0
    ds_read_b64_tr_b16 v[102:103], v39 offset:512
    v_mfma_f32_16x16x32_bf16 v[60:63], v[116:119], v[132:135], v[60:63]
    ds_read_b64_tr_b16 v[88:89], v36 offset:4096
    ds_read_b64_tr_b16 v[90:91], v36 offset:4608
    v_mfma_f32_16x16x32_bf16 v[48:51], v[120:123], v[136:139], v[48:51]
    ds_read_b64_tr_b16 v[92:93], v37 offset:4096
    ds_read_b64_tr_b16 v[94:95], v37 offset:4608
    v_mfma_f32_16x16x32_bf16 v[52:55], v[120:123], v[140:143], v[52:55]
    ds_read_b64_tr_b16 v[104:105], v38 offset:4096
    ds_read_b64_tr_b16 v[106:107], v38 offset:4608
    v_mfma_f32_16x16x32_bf16 v[56:59], v[124:127], v[136:139], v[56:59]
    ds_read_b64_tr_b16 v[108:109], v39 offset:4096
    ds_read_b64_tr_b16 v[110:111], v39 offset:4608
    v_mfma_f32_16x16x32_bf16 v[60:63], v[124:127], v[140:143], v[60:63]
    s_waitcnt lgkmcnt(0)
    s_add_u32 s24, s24, 1
    s_cmp_lt_u32 s24, 3
    s_cbranch_scc1 CG_loop0
    s_barrier
    v_add_u32 v36, s23, v28
    v_add_u32 v38, s23, v30
    v_add_u32 v37, s23, v29
    v_add_u32 v39, s23, v31
    s_add_u32 s23, s23, 16384
    s_and_b32 s23, s23, 0x1ffff
    ds_read_b64_tr_b16 v[112:113], v36 offset:0
    ds_read_b64_tr_b16 v[114:115], v36 offset:512
    v_mfma_f32_16x16x32_bf16 v[48:51], v[80:83], v[96:99], v[48:51]
    ds_read_b64_tr_b16 v[116:117], v37 offset:0
    ds_read_b64_tr_b16 v[118:119], v37 offset:512
    v_mfma_f32_16x16x32_bf16 v[52:55], v[80:83], v[100:103], v[52:55]
    ds_read_b64_tr_b16 v[128:129], v38 offset:0
    ds_read_b64_tr_b16 v[130:131], v38 offset:512
    v_mfma_f32_16x16x32_bf16 v[56:59], v[84:87], v[96:99], v[56:59]
    ds_read_b64_tr_b16 v[132:133], v39 offset:0
    ds_read_b64_tr_b16 v[134:135], v39 offset:512
    v_mfma_f32_16x16x32_bf16 v[60:63], v[84:87], v[100:103], v[60:63]
    ds_read_b64_tr_b16 v[120:121], v36 offset:4096
    ds_read_b64_tr_b16 v[122:123], v36 offset:4608
    v_mfma_f32_16x16x32_bf16 v[48:51], v[88:91], v[104:107], v[48:51]
    ds_read_b64_tr_b16 v[124:125], v37 offset:4096
    ds_read_b64_tr_b16 v[126:127], v37 offset:4608
    v_mfma_f32_16x16x32_bf16 v[52:55], v[88:91], v[108:111], v[52:55]
    ds_read_b64_tr_b16 v[136:137], v38 offset:4096
    ds_read_b64_tr_b16 v[138:139], v38 offset:4608
    v_mfma_f32_16x16x32_bf16 v[56:59], v[92:95], v[104:107], v[56:59]
    ds_read_b64_tr_b16 v[140:141], v39 offset:4096
    ds_read_b64_tr_b16 v[142:143], v39 offset:4608
    v_mfma_f32_16x16x32_bf16 v[60:63], v[92:95], v[108:111], v[60:63]
    s_waitcnt lgkmcnt(0)
    s_barrier
    v_add_u32 v36, s23, v28
    v_add_u32 v38, s23, v30
    v_add_u32 v37, s23, v29
    v_add_u32 v39, s23, v31
    s_add_u32 s23, s23, 16384
    s_and_b32 s23, s23, 0x1ffff
    ds_read_b64_tr_b16 v[80:81], v36 offset:0
    ds_read_b64_tr_b16 v[82:83], v36 offset:512
    v_mfma_f32_16x16x32_bf16 v[48:51], v[112:115], v[128:131], v[48:51]
    ds_read_b64_tr_b16 v[84:85], v37 offset:0
    ds_read_b64_tr_b16 v[86:87], v37 offset:512
    v_mfma_f32_16x16x32_bf16 v[52:55], v[112:115], v[132:135], v[52:55]
    ds_read_b64_tr_b16 v[96:97], v38 offset:0
    ds_read_b64_tr_b16 v[98:99], v38 offset:512
    v_mfma_f32_16x16x32_bf16 v[56:59], v[116:119], v[128:131], v[56:59]
    ds_read_b64_tr_b16 v[100:101], v39 offset:0
    ds_read_b64_tr_b16 v[102:103], v39 offset:512
    v_mfma_f32_16x16x32_bf16 v[60:63], v[116:119], v[132:135], v[60:63]
    ds_read_b64_tr_b16 v[88:89], v36 offset:4096
    ds_read_b64_tr_b16 v[90:91], v36 offset:4608
    v_mfma_f32_16x16x32_bf16 v[48:51], v[120:123], v[136:139], v[48:51]
    ds_read_b64_tr_b16 v[92:93], v37 offset:4096
    ds_read_b64_tr_b16 v[94:95], v37 offset:4608
    v_mfma_f32_16x16x32_bf16 v[52:55], v[120:123], v[140:143], v[52:55]
    ds_read_b64_tr_b16 v[104:105], v38 offset:4096
    ds_read_b64_tr_b16 v[106:107], v38 offset:4608
    v_mfma_f32_16x16x32_bf16 v[56:59], v[124:127], v[136:139], v[56:59]
    ds_read_b64_tr_b16 v[108:109], v39 offset:4096
    ds_read_b64_tr_b16 v[110:111], v39 offset:4608
    v_mfma_f32_16x16x32_bf16 v[60:63], v[124:127], v[140:143], v[60:63]
    s_waitcnt lgkmcnt(0)
    v_add_u32 v46, 32768, v45
    buffer_load_dword v47, v46, s[4:7], 0 offen
    s_barrier
    v_add_u32 v36, s23, v28
    v_add_u32 v38, s23, v30
    v_add_u32 v37, s23, v29
    v_add_u32 v39, s23, v31
    s_add_u32 s23, s23, 16384
    s_and_b32 s23, s23, 0x1ffff
    ds_read_b64_tr_b16 v[112:113], v36 offset:0
    ds_read_b64_tr_b16 v[114:115], v36 offset:512
    v_mfma_f32_16x16x32_bf16 v[48:51], v[80:83], v[96:99], v[48:51]
    ds_read_b64_tr_b16 v[116:117], v37 offset:0
    ds_read_b64_tr_b16 v[118:119], v37 offset:512
    v_mfma_f32_16x16x32_bf16 v[52:55], v[80:83], v[100:103], v[52:55]
    ds_read_b64_tr_b16 v[128:129], v38 offset:0
    ds_read_b64_tr_b16 v[130:131], v38 offset:512
    v_mfma_f32_16x16x32_bf16 v[56:59], v[84:87], v[96:99], v[56:59]
    ds_read_b64_tr_b16 v[132:133], v39 offset:0
    ds_read_b64_tr_b16 v[134:135], v39 offset:512
    v_mfma_f32_16x16x32_bf16 v[60:63], v[84:87], v[100:103], v[60:63]
    ds_read_b64_tr_b16 v[120:121], v36 offset:4096
    ds_read_b64_tr_b16 v[122:123], v36 offset:4608
    v_mfma_f32_16x16x32_bf16 v[48:51], v[88:91], v[104:107], v[48:51]
    ds_read_b64_tr_b16 v[124:125], v37 offset:4096
    ds_read_b64_tr_b16 v[126:127], v37 offset:4608
    v_mfma_f32_16x16x32_bf16 v[52:55], v[88:91], v[108:111], v[52:55]
    ds_read_b64_tr_b16 v[136:137], v38 offset:4096
    ds_read_b64_tr_b16 v[138:139], v38 offset:4608
    v_mfma_f32_16x16x32_bf16 v[56:59], v[92:95], v[104:107], v[56:59]
    ds_read_b64_tr_b16 v[140:141], v39 offset:4096
    ds_read_b64_tr_b16 v[142:143], v39 offset:4608
    v_mfma_f32_16x16x32_bf16 v[60:63], v[92:95], v[108:111], v[60:63]
    s_waitcnt lgkmcnt(0)
    s_barrier
    v_add_u32 v36, s23, v28
    v_add_u32 v38, s23, v30
    v_add_u32 v37, s23, v29
    v_add_u32 v39, s23, v31
    s_add_u32 s23, s23, 16384
    s_and_b32 s23, s23, 0x1ffff
    ds_read_b64_tr_b16 v[80:81], v36 offset:0
    ds_read_b64_tr_b16 v[82:83], v36 offset:512
    v_mfma_f32_16x16x32_bf16 v[48:51], v[112:115], v[128:131], v[48:51]
    ds_read_b64_tr_b16 v[84:85], v37 offset:0
    ds_read_b64_tr_b16 v[86:87], v37 offset:512
    v_mfma_f32_16x16x32_bf16 v[52:55], v[112:115], v[132:135], v[52:55]
    ds_read_b64_tr_b16 v[96:97], v38 offset:0
    ds_read_b64_tr_b16 v[98:99], v38 offset:512
    v_mfma_f32_16x16x32_bf16 v[56:59], v[116:119], v[128:131], v[56:59]
    ds_read_b64_tr_b16 v[100:101], v39 offset:0
    ds_read_b64_tr_b16 v[102:103], v39 offset:512
    v_mfma_f32_16x16x32_bf16 v[60:63], v[116:119], v[132:135], v[60:63]
    ds_read_b64_tr_b16 v[88:89], v36 offset:4096
    ds_read_b64_tr_b16 v[90:91], v36 offset:4608
    v_mfma_f32_16x16x32_bf16 v[48:51], v[120:123], v[136:139], v[48:51]
    ds_read_b64_tr_b16 v[92:93], v37 offset:4096
    ds_read_b64_tr_b16 v[94:95], v37 offset:4608
    v_mfma_f32_16x16x32_bf16 v[52:55], v[120:123], v[140:143], v[52:55]
    ds_read_b64_tr_b16 v[104:105], v38 offset:4096
    ds_read_b64_tr_b16 v[106:107], v38 offset:4608
    v_mfma_f32_16x16x32_bf16 v[56:59], v[124:127], v[136:139], v[56:59]
    ds_read_b64_tr_b16 v[108:109], v39 offset:4096
    ds_read_b64_tr_b16 v[110:111], v39 offset:4608
    v_mfma_f32_16x16x32_bf16 v[60:63], v[124:127], v[140:143], v[60:63]
    s_waitcnt lgkmcnt(0)
    s_barrier
    v_add_u32 v36, s23, v28
    v_add_u32 v38, s23, v30
    v_add_u32 v37, s23, v29
    v_add_u32 v39, s23, v31
    s_add_u32 s23, s23, 16384
    s_and_b32 s23, s23, 0x1ffff
    ds_read_b64_tr_b16 v[112:113], v36 offset:0
    ds_read_b64_tr_b16 v[114:115], v36 offset:512
    v_mfma_f32_16x16x32_bf16 v[48:51], v[80:83], v[96:99], v[48:51]
    ds_read_b64_tr_b16 v[116:117], v37 offset:0
    ds_read_b64_tr_b16 v[118:119], v37 offset:512
    v_mfma_f32_16x16x32_bf16 v[52:55], v[80:83], v[100:103], v[52:55]
    ds_read_b64_tr_b16 v[128:129], v38 offset:0
    ds_read_b64_tr_b16 v[130:131], v38 offset:512
    v_mfma_f32_16x16x32_bf16 v[56:59], v[84:87], v[96:99], v[56:59]
    ds_read_b64_tr_b16 v[132:133], v39 offset:0
    ds_read_b64_tr_b16 v[134:135], v39 offset:512
    v_mfma_f32_16x16x32_bf16 v[60:63], v[84:87], v[100:103], v[60:63]
    ds_read_b64_tr_b16 v[120:121], v36 offset:4096
    ds_read_b64_tr_b16 v[122:123], v36 offset:4608
    v_mfma_f32_16x16x32_bf16 v[48:51], v[88:91], v[104:107], v[48:51]
    ds_read_b64_tr_b16 v[124:125], v37 offset:4096
    ds_read_b64_tr_b16 v[126:127], v37 offset:4608
    v_mfma_f32_16x16x32_bf16 v[52:55], v[88:91], v[108:111], v[52:55]
    ds_read_b64_tr_b16 v[136:137], v38 offset:4096
    ds_read_b64_tr_b16 v[138:139], v38 offset:4608
    v_mfma_f32_16x16x32_bf16 v[56:59], v[92:95], v[104:107], v[56:59]
    ds_read_b64_tr_b16 v[140:141], v39 offset:4096
    ds_read_b64_tr_b16 v[142:143], v39 offset:4608
    v_mfma_f32_16x16x32_bf16 v[60:63], v[92:95], v[108:111], v[60:63]
    s_waitcnt lgkmcnt(0)
    s_barrier
    v_add_u32 v36, s23, v28
    v_add_u32 v38, s23, v30
    v_add_u32 v37, s23, v29
    v_add_u32 v39, s23, v31
    s_add_u32 s23, s23, 16384
    s_and_b32 s23, s23, 0x1ffff
    ds_read_b64_tr_b16 v[80:81], v36 offset:0
    ds_read_b64_tr_b16 v[82:83], v36 offset:512
    v_mfma_f32_16x16x32_bf16 v[48:51], v[112:115], v[128:131], v[48:51]
    ds_read_b64_tr_b16 v[84:85], v37 offset:0
    ds_read_b64_tr_b16 v[86:87], v37 offset:512
    v_mfma_f32_16x16x32_bf16 v[52:55], v[112:115], v[132:135], v[52:55]
    ds_read_b64_tr_b16 v[96:97], v38 offset:0
    ds_read_b64_tr_b16 v[98:99], v38 offset:512
    v_mfma_f32_16x16x32_bf16 v[56:59], v[116:119], v[128:131], v[56:59]
    ds_read_b64_tr_b16 v[100:101], v39 offset:0
    ds_read_b64_tr_b16 v[102:103], v39 offset:512
    v_mfma_f32_16x16x32_bf16 v[60:63], v[116:119], v[132:135], v[60:63]
    ds_read_b64_tr_b16 v[88:89], v36 offset:4096
    ds_read_b64_tr_b16 v[90:91], v36 offset:4608
    v_mfma_f32_16x16x32_bf16 v[48:51], v[120:123], v[136:139], v[48:51]
    ds_read_b64_tr_b16 v[92:93], v37 offset:4096
    ds_read_b64_tr_b16 v[94:95], v37 offset:4608
    v_mfma_f32_16x16x32_bf16 v[52:55], v[120:123], v[140:143], v[52:55]
    ds_read_b64_tr_b16 v[104:105], v38 offset:4096
    ds_read_b64_tr_b16 v[106:107], v38 offset:4608
    v_mfma_f32_16x16x32_bf16 v[56:59], v[124:127], v[136:139], v[56:59]
    ds_read_b64_tr_b16 v[108:109], v39 offset:4096
    ds_read_b64_tr_b16 v[110:111], v39 offset:4608
    v_mfma_f32_16x16x32_bf16 v[60:63], v[124:127], v[140:143], v[60:63]
    s_waitcnt lgkmcnt(0)
    v_min_u32 v4, 7, v1
    v_lshlrev_b32 v4, 6, v4
    v_add_u32 v4, s31, v4
    s_cmp_lg_u32 s25, 0
    s_cbranch_scc1 polli_done5
    buffer_load_dword v6, v4, s[92:95], 0 offen sc1
polli_done5:
    s_barrier
    v_add_u32 v36, s23, v28
    v_add_u32 v38, s23, v30
    v_add_u32 v37, s23, v29
    v_add_u32 v39, s23, v31
    s_add_u32 s23, s23, 16384
    s_and_b32 s23, s23, 0x1ffff
    ds_read_b64_tr_b16 v[112:113], v36 offset:0
    ds_read_b64_tr_b16 v[114:115], v36 offset:512
    v_mfma_f32_16x16x32_bf16 v[48:51], v[80:83], v[96:99], v[48:51]
    ds_read_b64_tr_b16 v[116:117], v37 offset:0
    ds_read_b64_tr_b16 v[118:119], v37 offset:512
    v_mfma_f32_16x16x32_bf16 v[52:55], v[80:83], v[100:103], v[52:55]
    ds_read_b64_tr_b16 v[128:129], v38 offset:0
    ds_read_b64_tr_b16 v[130:131], v38 offset:512
    v_mfma_f32_16x16x32_bf16 v[56:59], v[84:87], v[96:99], v[56:59]
    ds_read_b64_tr_b16 v[132:133], v39 offset:0
    ds_read_b64_tr_b16 v[134:135], v39 offset:512
    v_mfma_f32_16x16x32_bf16 v[60:63], v[84:87], v[100:103], v[60:63]
    ds_read_b64_tr_b16 v[120:121], v36 offset:4096
    ds_read_b64_tr_b16 v[122:123], v36 offset:4608
    v_mfma_f32_16x16x32_bf16 v[48:51], v[88:91], v[104:107], v[48:51]
    ds_read_b64_tr_b16 v[124:125], v37 offset:4096
    ds_read_b64_tr_b16 v[126:127], v37 offset:4608
    v_mfma_f32_16x16x32_bf16 v[52:55], v[88:91], v[108:111], v[52:55]
    ds_read_b64_tr_b16 v[136:137], v38 offset:4096
    ds_read_b64_tr_b16 v[138:139], v38 offset:4608
    v_mfma_f32_16x16x32_bf16 v[56:59], v[92:95], v[104:107], v[56:59]
    ds_read_b64_tr_b16 v[140:141], v39 offset:4096
    ds_read_b64_tr_b16 v[142:143], v39 offset:4608
    v_mfma_f32_16x16x32_bf16 v[60:63], v[92:95], v[108:111], v[60:63]
    s_waitcnt lgkmcnt(0)
    s_barrier
    v_add_u32 v36, s23, v28
    v_add_u32 v38, s23, v30
    v_add_u32 v37, s23, v29
    v_add_u32 v39, s23, v31
    s_add_u32 s23, s23, 16384
    s_and_b32 s23, s23, 0x1ffff
    ds_read_b64_tr_b16 v[80:81], v36 offset:0
    ds_read_b64_tr_b16 v[82:83], v36 offset:512
    v_mfma_f32_16x16x32_bf16 v[48:51], v[112:115], v[128:131], v[48:51]
    ds_read_b64_tr_b16 v[84:85], v37 offset:0
    ds_read_b64_tr_b16 v[86:87], v37 offset:512
    v_mfma_f32_16x16x32_bf16 v[52:55], v[112:115], v[132:135], v[52:55]
    ds_read_b64_tr_b16 v[96:97], v38 offset:0
    ds_read_b64_tr_b16 v[98:99], v38 offset:512
    v_mfma_f32_16x16x32_bf16 v[56:59], v[116:119], v[128:131], v[56:59]
    ds_read_b64_tr_b16 v[100:101], v39 offset:0
    ds_read_b64_tr_b16 v[102:103], v39 offset:512
    v_mfma_f32_16x16x32_bf16 v[60:63], v[116:119], v[132:135], v[60:63]
    ds_read_b64_tr_b16 v[88:89], v36 offset:4096
    ds_read_b64_tr_b16 v[90:91], v36 offset:4608
    v_mfma_f32_16x16x32_bf16 v[48:51], v[120:123], v[136:139], v[48:51]
    ds_read_b64_tr_b16 v[92:93], v37 offset:4096
    ds_read_b64_tr_b16 v[94:95], v37 offset:4608
    v_mfma_f32_16x16x32_bf16 v[52:55], v[120:123], v[140:143], v[52:55]
    ds_read_b64_tr_b16 v[104:105], v38 offset:4096
    ds_read_b64_tr_b16 v[106:107], v38 offset:4608
    v_mfma_f32_16x16x32_bf16 v[56:59], v[124:127], v[136:139], v[56:59]
    ds_read_b64_tr_b16 v[108:109], v39 offset:4096
    ds_read_b64_tr_b16 v[110:111], v39 offset:4608
    v_mfma_f32_16x16x32_bf16 v[60:63], v[124:127], v[140:143], v[60:63]
    s_waitcnt lgkmcnt(0)
    s_barrier
    v_add_u32 v36, s23, v28
    v_add_u32 v38, s23, v30
    v_add_u32 v37, s23, v29
    v_add_u32 v39, s23, v31
    s_add_u32 s23, s23, 16384
    s_and_b32 s23, s23, 0x1ffff
    ds_read_b64_tr_b16 v[112:113], v36 offset:0
    ds_read_b64_tr_b16 v[114:115], v36 offset:512
    v_mfma_f32_16x16x32_bf16 v[48:51], v[80:83], v[96:99], v[48:51]
    ds_read_b64_tr_b16 v[116:117], v37 offset:0
    ds_read_b64_tr_b16 v[118:119], v37 offset:512
    v_mfma_f32_16x16x32_bf16 v[52:55], v[80:83], v[100:103], v[52:55]
    ds_read_b64_tr_b16 v[128:129], v38 offset:0
    ds_read_b64_tr_b16 v[130:131], v38 offset:512
    v_mfma_f32_16x16x32_bf16 v[56:59], v[84:87], v[96:99], v[56:59]
    ds_read_b64_tr_b16 v[132:133], v39 offset:0
    ds_read_b64_tr_b16 v[134:135], v39 offset:512
    v_mfma_f32_16x16x32_bf16 v[60:63], v[84:87], v[100:103], v[60:63]
    ds_read_b64_tr_b16 v[120:121], v36 offset:4096
    ds_read_b64_tr_b16 v[122:123], v36 offset:4608
    v_mfma_f32_16x16x32_bf16 v[48:51], v[88:91], v[104:107], v[48:51]
    ds_read_b64_tr_b16 v[124:125], v37 offset:4096
    ds_read_b64_tr_b16 v[126:127], v37 offset:4608
    v_mfma_f32_16x16x32_bf16 v[52:55], v[88:91], v[108:111], v[52:55]
    ds_read_b64_tr_b16 v[136:137], v38 offset:4096
    ds_read_b64_tr_b16 v[138:139], v38 offset:4608
    v_mfma_f32_16x16x32_bf16 v[56:59], v[92:95], v[104:107], v[56:59]
    ds_read_b64_tr_b16 v[140:141], v39 offset:4096
    ds_read_b64_tr_b16 v[142:143], v39 offset:4608
    v_mfma_f32_16x16x32_bf16 v[60:63], v[92:95], v[108:111], v[60:63]
    s_waitcnt lgkmcnt(0)
    s_cmp_lg_u32 s25, 0
    s_cbranch_scc1 poll_done6
    s_mov_b32 s90, 0
    s_branch poll_chk6
poll_loop6:
    buffer_load_dword v6, v4, s[92:95], 0 offen sc1
poll_chk6:
    s_waitcnt vmcnt(0)
    v_cmp_ne_u32 vcc, s88, v6
    s_add_u32 s90, s90, 1
    s_cmp_ge_u32 s90, 200000
    s_cbranch_scc1 poll_done6
    s_cmp_eq_u64 vcc, 0
    s_cbranch_scc1 poll_done6
    s_sleep 2
    s_branch poll_loop6
poll_done6:
    s_barrier
    v_add_u32 v36, s23, v28
    v_add_u32 v38, s23, v30
    v_add_u32 v37, s23, v29
    v_add_u32 v39, s23, v31
    s_add_u32 s23, s23, 16384
    s_and_b32 s23, s23, 0x1ffff
    ds_read_b64_tr_b16 v[80:81], v36 offset:0
    ds_read_b64_tr_b16 v[82:83], v36 offset:512
    v_mfma_f32_16x16x32_bf16 v[48:51], v[112:115], v[128:131], v[48:51]
    ds_read_b64_tr_b16 v[84:85], v37 offset:0
    ds_read_b64_tr_b16 v[86:87], v37 offset:512
    v_mfma_f32_16x16x32_bf16 v[52:55], v[112:115], v[132:135], v[52:55]
    ds_read_b64_tr_b16 v[96:97], v38 offset:0
    ds_read_b64_tr_b16 v[98:99], v38 offset:512
    v_mfma_f32_16x16x32_bf16 v[56:59], v[116:119], v[128:131], v[56:59]
    ds_read_b64_tr_b16 v[100:101], v39 offset:0
    ds_read_b64_tr_b16 v[102:103], v39 offset:512
    v_mfma_f32_16x16x32_bf16 v[60:63], v[116:119], v[132:135], v[60:63]
    ds_read_b64_tr_b16 v[88:89], v36 offset:4096
    ds_read_b64_tr_b16 v[90:91], v36 offset:4608
    v_mfma_f32_16x16x32_bf16 v[48:51], v[120:123], v[136:139], v[48:51]
    ds_read_b64_tr_b16 v[92:93], v37 offset:4096
    ds_read_b64_tr_b16 v[94:95], v37 offset:4608
    v_mfma_f32_16x16x32_bf16 v[52:55], v[120:123], v[140:143], v[52:55]
    ds_read_b64_tr_b16 v[104:105], v38 offset:4096
    ds_read_b64_tr_b16 v[106:107], v38 offset:4608
    v_mfma_f32_16x16x32_bf16 v[56:59], v[124:127], v[136:139], v[56:59]
    ds_read_b64_tr_b16 v[108:109], v39 offset:4096
    ds_read_b64_tr_b16 v[110:111], v39 offset:4608
    v_mfma_f32_16x16x32_bf16 v[60:63], v[124:127], v[140:143], v[60:63]
    s_waitcnt lgkmcnt(0)
    s_mov_b32 s24, 0
CG_loop1:
    s_barrier
    v_add_u32 v36, s23, v28
    v_add_u32 v38, s23, v30
    v_add_u32 v37, s23, v29
    v_add_u32 v39, s23, v31
    s_add_u32 s23, s23, 16384
    s_and_b32 s23, s23, 0x1ffff
    ds_read_b64_tr_b16 v[112:113], v36 offset:0
    ds_read_b64_tr_b16 v[114:115], v36 offset:512
    v_mfma_f32_16x16x32_bf16 v[48:51], v[80:83], v[96:99], v[48:51]
    ds_read_b64_tr_b16 v[116:117], v37 offset:0
    ds_read_b64_tr_b16 v[118:119], v37 offset:512
    v_mfma_f32_16x16x32_bf16 v[52:55], v[80:83], v[100:103], v[52:55]
    ds_read_b64_tr_b16 v[128:129], v38 offset:0
    ds_read_b64_tr_b16 v[130:131], v38 offset:512
    v_mfma_f32_16x16x32_bf16 v[56:59], v[84:87], v[96:99], v[56:59]
    ds_read_b64_tr_b16 v[132:133], v39 offset:0
    ds_read_b64_tr_b16 v[134:135], v39 offset:512
    v_mfma_f32_16x16x32_bf16 v[60:63], v[84:87], v[100:103], v[60:63]
    ds_read_b64_tr_b16 v[120:121], v36 offset:4096
    ds_read_b64_tr_b16 v[122:123], v36 offset:4608
    v_mfma_f32_16x16x32_bf16 v[48:51], v[88:91], v[104:107], v[48:51]
    ds_read_b64_tr_b16 v[124:125], v37 offset:4096
    ds_read_b64_tr_b16 v[126:127], v37 offset:4608
    v_mfma_f32_16x16x32_bf16 v[52:55], v[88:91], v[108:111], v[52:55]
    ds_read_b64_tr_b16 v[136:137], v38 offset:4096
    ds_read_b64_tr_b16 v[138:139], v38 offset:4608
    v_mfma_f32_16x16x32_bf16 v[56:59], v[92:95], v[104:107], v[56:59]
    ds_read_b64_tr_b16 v[140:141], v39 offset:4096
    ds_read_b64_tr_b16 v[142:143], v39 offset:4608
    v_mfma_f32_16x16x32_bf16 v[60:63], v[92:95], v[108:111], v[60:63]
    s_waitcnt lgkmcnt(0)
    s_barrier
    v_add_u32 v36, s23, v28
    v_add_u32 v38, s23, v30
    v_add_u32 v37, s23, v29
    v_add_u32 v39, s23, v31
    s_add_u32 s23, s23, 16384
    s_and_b32 s23, s23, 0x1ffff
    ds_read_b64_tr_b16 v[80:81], v36 offset:0
    ds_read_b64_tr_b16 v[82:83], v36 offset:512
    v_mfma_f32_16x16x32_bf16 v[48:51], v[112:115], v[128:131], v[48:51]
    ds_read_b64_tr_b16 v[84:85], v37 offset:0
    ds_read_b64_tr_b16 v[86:87], v37 offset:512
    v_mfma_f32_16x16x32_bf16 v[52:55], v[112:115], v[132:135], v[52:55]
    ds_read_b64_tr_b16 v[96:97], v38 offset:0
    ds_read_b64_tr_b16 v[98:99], v38 offset:512
    v_mfma_f32_16x16x32_bf16 v[56:59], v[116:119], v[128:131], v[56:59]
    ds_read_b64_tr_b16 v[100:101], v39 offset:0
    ds_read_b64_tr_b16 v[102:103], v39 offset:512
    v_mfma_f32_16x16x32_bf16 v[60:63], v[116:119], v[132:135], v[60:63]
    ds_read_b64_tr_b16 v[88:89], v36 offset:4096
    ds_read_b64_tr_b16 v[90:91], v36 offset:4608
    v_mfma_f32_16x16x32_bf16 v[48:51], v[120:123], v[136:139], v[48:51]
    ds_read_b64_tr_b16 v[92:93], v37 offset:4096
    ds_read_b64_tr_b16 v[94:95], v37 offset:4608
    v_mfma_f32_16x16x32_bf16 v[52:55], v[120:123], v[140:143], v[52:55]
    ds_read_b64_tr_b16 v[104:105], v38 offset:4096
    ds_read_b64_tr_b16 v[106:107], v38 offset:4608
    v_mfma_f32_16x16x32_bf16 v[56:59], v[124:127], v[136:139], v[56:59]
    ds_read_b64_tr_b16 v[108:109], v39 offset:4096
    ds_read_b64_tr_b16 v[110:111], v39 offset:4608
    v_mfma_f32_16x16x32_bf16 v[60:63], v[124:127], v[140:143], v[60:63]
    s_waitcnt lgkmcnt(0)
    s_add_u32 s24, s24, 1
    s_cmp_lt_u32 s24, 3
    s_cbranch_scc1 CG_loop1
    s_barrier
    v_add_u32 v36, s23, v28
    v_add_u32 v38, s23, v30
    v_add_u32 v37, s23, v29
    v_add_u32 v39, s23, v31
    s_add_u32 s23, s23, 16384
    s_and_b32 s23, s23, 0x1ffff
    ds_read_b64_tr_b16 v[112:113], v36 offset:0
    ds_read_b64_tr_b16 v[114:115], v36 offset:512
    v_mfma_f32_16x16x32_bf16 v[48:51], v[80:83], v[96:99], v[48:51]
    ds_read_b64_tr_b16 v[116:117], v37 offset:0
    ds_read_b64_tr_b16 v[118:119], v37 offset:512
    v_mfma_f32_16x16x32_bf16 v[52:55], v[80:83], v[100:103], v[52:55]
    ds_read_b64_tr_b16 v[128:129], v38 offset:0
    ds_read_b64_tr_b16 v[130:131], v38 offset:512
    v_mfma_f32_16x16x32_bf16 v[56:59], v[84:87], v[96:99], v[56:59]
    ds_read_b64_tr_b16 v[132:133], v39 offset:0
    ds_read_b64_tr_b16 v[134:135], v39 offset:512
    v_mfma_f32_16x16x32_bf16 v[60:63], v[84:87], v[100:103], v[60:63]
    ds_read_b64_tr_b16 v[120:121], v36 offset:4096
    ds_read_b64_tr_b16 v[122:123], v36 offset:4608
    v_mfma_f32_16x16x32_bf16 v[48:51], v[88:91], v[104:107], v[48:51]
    ds_read_b64_tr_b16 v[124:125], v37 offset:4096
    ds_read_b64_tr_b16 v[126:127], v37 offset:4608
    v_mfma_f32_16x16x32_bf16 v[52:55], v[88:91], v[108:111], v[52:55]
    ds_read_b64_tr_b16 v[136:137], v38 offset:4096
    ds_read_b64_tr_b16 v[138:139], v38 offset:4608
    v_mfma_f32_16x16x32_bf16 v[56:59], v[92:95], v[104:107], v[56:59]
    ds_read_b64_tr_b16 v[140:141], v39 offset:4096
    ds_read_b64_tr_b16 v[142:143], v39 offset:4608
    v_mfma_f32_16x16x32_bf16 v[60:63], v[92:95], v[108:111], v[60:63]
    s_waitcnt lgkmcnt(0)
    s_barrier
    v_add_u32 v36, s23, v28
    v_add_u32 v38, s23, v34
    v_add_u32 v37, s23, v29
    v_add_u32 v39, s23, v35
    s_add_u32 s23, s23, 16384
    s_and_b32 s23, s23, 0x1ffff
    ds_read_b64_tr_b16 v[80:81], v36 offset:0
    ds_read_b64_tr_b16 v[82:83], v36 offset:512
    v_mfma_f32_16x16x32_bf16 v[48:51], v[112:115], v[128:131], v[48:51]
    ds_read_b64_tr_b16 v[84:85], v37 offset:0
    v_mfma_f32_16x16x32_bf16 v[52:55], v[112:115], v[132:135], v[52:55]
    ds_read_b64_tr_b16 v[86:87], v37 offset:512
    ds_read_b128 v[96:99], v38 offset:0
    v_mfma_f32_16x16x32_bf16 v[56:59], v[116:119], v[128:131], v[56:59]
    ds_read_b128 v[100:103], v38 offset:2048
    v_mfma_f32_16x16x32_bf16 v[60:63], v[116:119], v[132:135], v[60:63]
    ds_read_b64_tr_b16 v[88:89], v36 offset:4096
    ds_read_b64_tr_b16 v[90:91], v36 offset:4608
    v_mfma_f32_16x16x32_bf16 v[48:51], v[120:123], v[136:139], v[48:51]
    ds_read_b64_tr_b16 v[92:93], v37 offset:4096
    v_mfma_f32_16x16x32_bf16 v[52:55], v[120:123], v[140:143], v[52:55]
    ds_read_b64_tr_b16 v[94:95], v37 offset:4608
    ds_read_b128 v[104:107], v39 offset:0
    v_mfma_f32_16x16x32_bf16 v[56:59], v[124:127], v[136:139], v[56:59]
    ds_read_b128 v[108:111], v39 offset:2048
    v_mfma_f32_16x16x32_bf16 v[60:63], v[124:127], v[140:143], v[60:63]
    s_waitcnt lgkmcnt(0)
    s_mov_b32 s26, 0x40135761
    s_mov_b32 s27, 0x3dd2d3e8
    v_and_b32 v8, 15, v1
    v_lshl_add_u32 v8, v27, 5, v8
    v_lshl_add_u32 v8, v8, 7, v13
    v_add_u32 v8, 131072, v8
    v_lshrrev_b32 v9, 3, v1
    v_lshl_add_u32 v9, v2, 4, v9
    v_and_b32 v10, 7, v1
    v_lshlrev_b32 v10, 4, v10
    v_lshl_add_u32 v11, v9, 7, v10
    v_add_u32 v11, 131072, v11
    s_lshl_b32 s37, s66, 6
    v_add_u32 v9, s37, v9
    s_movk_i32 s37, 3584
    v_mul_lo_u32 v9, v9, s37
    v_add3_u32 v9, v9, v10, s65
    v_add_u32 v10, 28672, v9
    s_waitcnt vmcnt(0)
    s_nop 7
    v_lshlrev_b32 v152, 16, v14
    v_and_b32 v153, 0xffff0000, v14
    v_lshlrev_b32 v154, 16, v15
    v_and_b32 v155, 0xffff0000, v15
    v_cvt_pk_bf16_f32 v144, v48, v49
    v_cvt_pk_bf16_f32 v145, v50, v51
    v_lshlrev_b32 v146, 16, v144
    v_and_b32 v147, 0xffff0000, v144
    v_lshlrev_b32 v148, 16, v145
    v_and_b32 v149, 0xffff0000, v145
    v_add_f32 v146, v146, v152
    v_add_f32 v147, v147, v153
    v_add_f32 v148, v148, v154
    v_add_f32 v149, v149, v155
    v_cvt_pk_bf16_f32 v144, v146, v147
    v_cvt_pk_bf16_f32 v145, v148, v149
    v_lshlrev_b32 v146, 16, v144
    v_and_b32 v147, 0xffff0000, v144
    v_lshlrev_b32 v148, 16, v145
    v_and_b32 v149, 0xffff0000, v145
    v_mul_f32 v150, v146, v146
    v_mov_b32 v151, s26
    v_fma_f32 v150, v150, s27, v151
    v_mul_f32 v150, v150, v146
    v_exp_f32 v150, -v150
    s_nop 0
    v_add_f32 v150, 1.0, v150
    v_rcp_f32 v150, v150
    s_nop 0
    v_mul_f32 v146, v146, v150
    v_mul_f32 v150, v147, v147
    v_mov_b32 v151, s26
    v_fma_f32 v150, v150, s27, v151
    v_mul_f32 v150, v150, v147
    v_exp_f32 v150, -v150
    s_nop 0
    v_add_f32 v150, 1.0, v150
    v_rcp_f32 v150, v150
    s_nop 0
    v_mul_f32 v147, v147, v150
    v_mul_f32 v150, v148, v148
    v_mov_b32 v151, s26
    v_fma_f32 v150, v150, s27, v151
    v_mul_f32 v150, v150, v148
    v_exp_f32 v150, -v150
    s_nop 0
    v_add_f32 v150, 1.0, v150
    v_rcp_f32 v150, v150
    s_nop 0
    v_mul_f32 v148, v148, v150
    v_mul_f32 v150, v149, v149
    v_mov_b32 v151, s26
    v_fma_f32 v150, v150, s27, v151
    v_mul_f32 v150, v150, v149
    v_exp_f32 v150, -v150
    s_nop 0
    v_add_f32 v150, 1.0, v150
    v_rcp_f32 v150, v150
    s_nop 0
    v_mul_f32 v149, v149, v150
    v_cvt_pk_bf16_f32 v156, v146, v147
    v_cvt_pk_bf16_f32 v157, v148, v149
    ds_write_b64 v8, v[156:157] offset:0
    v_cvt_pk_bf16_f32 v144, v52, v53
    v_cvt_pk_bf16_f32 v145, v54, v55
    v_lshlrev_b32 v146, 16, v144
    v_and_b32 v147, 0xffff0000, v144
    v_lshlrev_b32 v148, 16, v145
    v_and_b32 v149, 0xffff0000, v145
    v_add_f32 v146, v146, v152
    v_add_f32 v147, v147, v153
    v_add_f32 v148, v148, v154
    v_add_f32 v149, v149, v155
    v_cvt_pk_bf16_f32 v144, v146, v147
    v_cvt_pk_bf16_f32 v145, v148, v149
    v_lshlrev_b32 v146, 16, v144
    v_and_b32 v147, 0xffff0000, v144
    v_lshlrev_b32 v148, 16, v145
    v_and_b32 v149, 0xffff0000, v145
    v_mul_f32 v150, v146, v146
    v_mov_b32 v151, s26
    v_fma_f32 v150, v150, s27, v151
    v_mul_f32 v150, v150, v146
    v_exp_f32 v150, -v150
    s_nop 0
    v_add_f32 v150, 1.0, v150
    v_rcp_f32 v150, v150
    s_nop 0
    v_mul_f32 v146, v146, v150
    v_mul_f32 v150, v147, v147
    v_mov_b32 v151, s26
    v_fma_f32 v150, v150, s27, v151
    v_mul_f32 v150, v150, v147
    v_exp_f32 v150, -v150
    s_nop 0
    v_add_f32 v150, 1.0, v150
    v_rcp_f32 v150, v150
    s_nop 0
    v_mul_f32 v147, v147, v150
    v_mul_f32 v150, v148, v148
    v_mov_b32 v151, s26
    v_fma_f32 v150, v150, s27, v151
    v_mul_f32 v150, v150, v148
    v_exp_f32 v150, -v150
    s_nop 0
    v_add_f32 v150, 1.0, v150
    v_rcp_f32 v150, v150
    s_nop 0
    v_mul_f32 v148, v148, v150
    v_mul_f32 v150, v149, v149
    v_mov_b32 v151, s26
    v_fma_f32 v150, v150, s27, v151
    v_mul_f32 v150, v150, v149
    v_exp_f32 v150, -v150
    s_nop 0
    v_add_f32 v150, 1.0, v150
    v_rcp_f32 v150, v150
    s_nop 0
    v_mul_f32 v149, v149, v150
    v_cvt_pk_bf16_f32 v158, v146, v147
    v_cvt_pk_bf16_f32 v159, v148, v149
    ds_write_b64 v8, v[158:159] offset:2048
    v_lshlrev_b32 v152, 16, v16
    v_and_b32 v153, 0xffff0000, v16
    v_lshlrev_b32 v154, 16, v17
    v_and_b32 v155, 0xffff0000, v17
    v_cvt_pk_bf16_f32 v144, v56, v57
    v_cvt_pk_bf16_f32 v145, v58, v59
    v_lshlrev_b32 v146, 16, v144
    v_and_b32 v147, 0xffff0000, v144
    v_lshlrev_b32 v148, 16, v145
    v_and_b32 v149, 0xffff0000, v145
    v_add_f32 v146, v146, v152
    v_add_f32 v147, v147, v153
    v_add_f32 v148, v148, v154
    v_add_f32 v149, v149, v155
    v_cvt_pk_bf16_f32 v144, v146, v147
    v_cvt_pk_bf16_f32 v145, v148, v149
    v_lshlrev_b32 v146, 16, v144
    v_and_b32 v147, 0xffff0000, v144
    v_lshlrev_b32 v148, 16, v145
    v_and_b32 v149, 0xffff0000, v145
    v_mul_f32 v150, v146, v146
    v_mov_b32 v151, s26
    v_fma_f32 v150, v150, s27, v151
    v_mul_f32 v150, v150, v146
    v_exp_f32 v150, -v150
    s_nop 0
    v_add_f32 v150, 1.0, v150
    v_rcp_f32 v150, v150
    s_nop 0
    v_mul_f32 v146, v146, v150
    v_mul_f32 v150, v147, v147
    v_mov_b32 v151, s26
    v_fma_f32 v150, v150, s27, v151
    v_mul_f32 v150, v150, v147
    v_exp_f32 v150, -v150
    s_nop 0
    v_add_f32 v150, 1.0, v150
    v_rcp_f32 v150, v150
    s_nop 0
    v_mul_f32 v147, v147, v150
    v_mul_f32 v150, v148, v148
    v_mov_b32 v151, s26
    v_fma_f32 v150, v150, s27, v151
    v_mul_f32 v150, v150, v148
    v_exp_f32 v150, -v150
    s_nop 0
    v_add_f32 v150, 1.0, v150
    v_rcp_f32 v150, v150
    s_nop 0
    v_mul_f32 v148, v148, v150
    v_mul_f32 v150, v149, v149
    v_mov_b32 v151, s26
    v_fma_f32 v150, v150, s27, v151
    v_mul_f32 v150, v150, v149
    v_exp_f32 v150, -v150
    s_nop 0
    v_add_f32 v150, 1.0, v150
    v_rcp_f32 v150, v150
    s_nop 0
    v_mul_f32 v149, v149, v150
    v_cvt_pk_bf16_f32 v160, v146, v147
    v_cvt_pk_bf16_f32 v161, v148, v149
    ds_write_b64 v8, v[160:161] offset:32
    v_cvt_pk_bf16_f32 v144, v60, v61
    v_cvt_pk_bf16_f32 v145, v62, v63
    v_lshlrev_b32 v146, 16, v144
    v_and_b32 v147, 0xffff0000, v144
    v_lshlrev_b32 v148, 16, v145
    v_and_b32 v149, 0xffff0000, v145
    v_add_f32 v146, v146, v152
    v_add_f32 v147, v147, v153
    v_add_f32 v148, v148, v154
    v_add_f32 v149, v149, v155
    v_cvt_pk_bf16_f32 v144, v146, v147
    v_cvt_pk_bf16_f32 v145, v148, v149
    v_lshlrev_b32 v146, 16, v144
    v_and_b32 v147, 0xffff0000, v144
    v_lshlrev_b32 v148, 16, v145
    v_and_b32 v149, 0xffff0000, v145
    v_mul_f32 v150, v146, v146
    v_mov_b32 v151, s26
    v_fma_f32 v150, v150, s27, v151
    v_mul_f32 v150, v150, v146
    v_exp_f32 v150, -v150
    s_nop 0
    v_add_f32 v150, 1.0, v150
    v_rcp_f32 v150, v150
    s_nop 0
    v_mul_f32 v146, v146, v150
    v_mul_f32 v150, v147, v147
    v_mov_b32 v151, s26
    v_fma_f32 v150, v150, s27, v151
    v_mul_f32 v150, v150, v147
    v_exp_f32 v150, -v150
    s_nop 0
    v_add_f32 v150, 1.0, v150
    v_rcp_f32 v150, v150
    s_nop 0
    v_mul_f32 v147, v147, v150
    v_mul_f32 v150, v148, v148
    v_mov_b32 v151, s26
    v_fma_f32 v150, v150, s27, v151
    v_mul_f32 v150, v150, v148
    v_exp_f32 v150, -v150
    s_nop 0
    v_add_f32 v150, 1.0, v150
    v_rcp_f32 v150, v150
    s_nop 0
    v_mul_f32 v148, v148, v150
    v_mul_f32 v150, v149, v149
    v_mov_b32 v151, s26
    v_fma_f32 v150, v150, s27, v151
    v_mul_f32 v150, v150, v149
    v_exp_f32 v150, -v150
    s_nop 0
    v_add_f32 v150, 1.0, v150
    v_rcp_f32 v150, v150
    s_nop 0
    v_mul_f32 v149, v149, v150
    v_cvt_pk_bf16_f32 v162, v146, v147
    v_cvt_pk_bf16_f32 v163, v148, v149
    ds_write_b64 v8, v[162:163] offset:2080
    v_mov_b32 v48, 0
    v_mov_b32 v49, 0
    v_mov_b32 v50, 0
    v_mov_b32 v51, 0
    v_mov_b32 v52, 0
    v_mov_b32 v53, 0
    v_mov_b32 v54, 0
    v_mov_b32 v55, 0
    v_mov_b32 v56, 0
    v_mov_b32 v57, 0
    v_mov_b32 v58, 0
    v_mov_b32 v59, 0
    v_mov_b32 v60, 0
    v_mov_b32 v61, 0
    v_mov_b32 v62, 0
    v_mov_b32 v63, 0
    s_lshl_b32 s89, s66, 5
    s_lshr_b32 s26, s64, 3
    s_add_u32 s89, s89, s26
    s_lshl_b32 s89, s89, 6
    s_add_u32 s89, s89, 32768
    s_waitcnt lgkmcnt(0)
    s_barrier
    v_add_u32 v36, s23, v28
    v_add_u32 v38, s23, v34
    v_add_u32 v37, s23, v29
    v_add_u32 v39, s23, v35
    s_add_u32 s23, s23, 16384
    s_and_b32 s23, s23, 0x1ffff
    ds_read_b64_tr_b16 v[112:113], v36 offset:0
    ds_read_b64_tr_b16 v[114:115], v36 offset:512
    v_mfma_f32_16x16x32_bf16 v[64:67], v[80:83], v[96:99], v[64:67]
    ds_read_b64_tr_b16 v[116:117], v37 offset:0
    v_mfma_f32_16x16x32_bf16 v[68:71], v[80:83], v[100:103], v[68:71]
    ds_read_b64_tr_b16 v[118:119], v37 offset:512
    ds_read_b128 v[128:131], v38 offset:0
    v_mfma_f32_16x16x32_bf16 v[72:75], v[84:87], v[96:99], v[72:75]
    ds_read_b128 v[132:135], v38 offset:2048
    v_mfma_f32_16x16x32_bf16 v[76:79], v[84:87], v[100:103], v[76:79]
    ds_read_b64_tr_b16 v[120:121], v36 offset:4096
    ds_read_b64_tr_b16 v[122:123], v36 offset:4608
    v_mfma_f32_16x16x32_bf16 v[64:67], v[88:91], v[104:107], v[64:67]
    ds_read_b64_tr_b16 v[124:125], v37 offset:4096
    v_mfma_f32_16x16x32_bf16 v[68:71], v[88:91], v[108:111], v[68:71]
    ds_read_b64_tr_b16 v[126:127], v37 offset:4608
    ds_read_b128 v[136:139], v39 offset:0
    v_mfma_f32_16x16x32_bf16 v[72:75], v[92:95], v[104:107], v[72:75]
    ds_read_b128 v[140:143], v39 offset:2048
    v_mfma_f32_16x16x32_bf16 v[76:79], v[92:95], v[108:111], v[76:79]
    s_waitcnt lgkmcnt(0)
    ds_read_b128 v[144:147], v11
    ds_read_b128 v[148:151], v11 offset:1024
    s_waitcnt lgkmcnt(0)
    buffer_store_dwordx4 v[144:147], v9, s[12:15], 0 offen sc1
    buffer_store_dwordx4 v[148:151], v10, s[12:15], 0 offen sc1
    s_barrier
    v_add_u32 v36, s23, v28
    v_add_u32 v38, s23, v34
    v_add_u32 v37, s23, v29
    v_add_u32 v39, s23, v35
    s_add_u32 s23, s23, 16384
    s_and_b32 s23, s23, 0x1ffff
    ds_read_b64_tr_b16 v[80:81], v36 offset:0
    ds_read_b64_tr_b16 v[82:83], v36 offset:512
    v_mfma_f32_16x16x32_bf16 v[64:67], v[112:115], v[128:131], v[64:67]
    ds_read_b64_tr_b16 v[84:85], v37 offset:0
    v_mfma_f32_16x16x32_bf16 v[68:71], v[112:115], v[132:135], v[68:71]
    ds_read_b64_tr_b16 v[86:87], v37 offset:512
    ds_read_b128 v[96:99], v38 offset:0
    v_mfma_f32_16x16x32_bf16 v[72:75], v[116:119], v[128:131], v[72:75]
    ds_read_b128 v[100:103], v38 offset:2048
    v_mfma_f32_16x16x32_bf16 v[76:79], v[116:119], v[132:135], v[76:79]
    ds_read_b64_tr_b16 v[88:89], v36 offset:4096
    ds_read_b64_tr_b16 v[90:91], v36 offset:4608
    v_mfma_f32_16x16x32_bf16 v[64:67], v[120:123], v[136:139], v[64:67]
    ds_read_b64_tr_b16 v[92:93], v37 offset:4096
    v_mfma_f32_16x16x32_bf16 v[68:71], v[120:123], v[140:143], v[68:71]
    ds_read_b64_tr_b16 v[94:95], v37 offset:4608
    ds_read_b128 v[104:107], v39 offset:0
    v_mfma_f32_16x16x32_bf16 v[72:75], v[124:127], v[136:139], v[72:75]
    ds_read_b128 v[108:111], v39 offset:2048
    v_mfma_f32_16x16x32_bf16 v[76:79], v[124:127], v[140:143], v[76:79]
    s_waitcnt lgkmcnt(0)
    s_waitcnt vmcnt(0)
    s_barrier
    v_add_u32 v36, s23, v28
    v_add_u32 v38, s23, v34
    v_add_u32 v37, s23, v29
    v_add_u32 v39, s23, v35
    s_add_u32 s23, s23, 16384
    s_and_b32 s23, s23, 0x1ffff
    ds_read_b64_tr_b16 v[112:113], v36 offset:0
    ds_read_b64_tr_b16 v[114:115], v36 offset:512
    v_mfma_f32_16x16x32_bf16 v[64:67], v[80:83], v[96:99], v[64:67]
    ds_read_b64_tr_b16 v[116:117], v37 offset:0
    v_mfma_f32_16x16x32_bf16 v[68:71], v[80:83], v[100:103], v[68:71]
    ds_read_b64_tr_b16 v[118:119], v37 offset:512
    ds_read_b128 v[128:131], v38 offset:0
    v_mfma_f32_16x16x32_bf16 v[72:75], v[84:87], v[96:99], v[72:75]
    ds_read_b128 v[132:135], v38 offset:2048
    v_mfma_f32_16x16x32_bf16 v[76:79], v[84:87], v[100:103], v[76:79]
    ds_read_b64_tr_b16 v[120:121], v36 offset:4096
    ds_read_b64_tr_b16 v[122:123], v36 offset:4608
    v_mfma_f32_16x16x32_bf16 v[64:67], v[88:91], v[104:107], v[64:67]
    ds_read_b64_tr_b16 v[124:125], v37 offset:4096
    v_mfma_f32_16x16x32_bf16 v[68:71], v[88:91], v[108:111], v[68:71]
    ds_read_b64_tr_b16 v[126:127], v37 offset:4608
    ds_read_b128 v[136:139], v39 offset:0
    v_mfma_f32_16x16x32_bf16 v[72:75], v[92:95], v[104:107], v[72:75]
    ds_read_b128 v[140:143], v39 offset:2048
    v_mfma_f32_16x16x32_bf16 v[76:79], v[92:95], v[108:111], v[76:79]
    s_waitcnt lgkmcnt(0)
    s_cmp_lg_u32 s25, 0
    s_cbranch_scc1 flag_done7
    v_mov_b32 v4, s89
    v_mov_b32 v5, s88
    s_mov_b64 exec, 1
    buffer_store_dword v5, v4, s[92:95], 0 offen sc1
    s_mov_b64 exec, -1
flag_done7:
    s_branch C_ph3
C_skip:
    s_waitcnt vmcnt(0)
    s_barrier
    s_cmp_lg_u32 s25, 0
    s_cbranch_scc1 flag_done8
    v_mov_b32 v4, s89
    v_mov_b32 v5, s88
    s_mov_b64 exec, 1
    buffer_store_dword v5, v4, s[92:95], 0 offen sc1
    s_mov_b64 exec, -1
flag_done8:
    s_cmp_lg_u32 s25, 0
    s_cbranch_scc1 poll_done9
    s_mov_b32 s90, 0
    v_min_u32 v4, 7, v1
    v_lshlrev_b32 v4, 6, v4
    v_add_u32 v4, s31, v4
poll_loop9:
    buffer_load_dword v6, v4, s[92:95], 0 offen sc1
poll_chk9:
    s_waitcnt vmcnt(0)
    v_cmp_ne_u32 vcc, s88, v6
    s_add_u32 s90, s90, 1
    s_cmp_ge_u32 s90, 200000
    s_cbranch_scc1 poll_done9
    s_cmp_eq_u64 vcc, 0
    s_cbranch_scc1 poll_done9
    s_sleep 2
    s_branch poll_loop9
poll_done9:
    s_barrier
    s_barrier
    v_add_u32 v36, s23, v28
    v_add_u32 v38, s23, v34
    v_add_u32 v37, s23, v29
    v_add_u32 v39, s23, v35
    s_add_u32 s23, s23, 16384
    s_and_b32 s23, s23, 0x1ffff
    ds_read_b64_tr_b16 v[80:81], v36 offset:0
    ds_read_b64_tr_b16 v[82:83], v36 offset:512
    ds_read_b64_tr_b16 v[84:85], v37 offset:0
    ds_read_b64_tr_b16 v[86:87], v37 offset:512
    ds_read_b128 v[96:99], v38 offset:0
    ds_read_b128 v[100:103], v38 offset:2048
    ds_read_b64_tr_b16 v[88:89], v36 offset:4096
    ds_read_b64_tr_b16 v[90:91], v36 offset:4608
    ds_read_b64_tr_b16 v[92:93], v37 offset:4096
    ds_read_b64_tr_b16 v[94:95], v37 offset:4608
    ds_read_b128 v[104:107], v39 offset:0
    ds_read_b128 v[108:111], v39 offset:2048
    s_waitcnt lgkmcnt(0)
    s_barrier
    v_add_u32 v36, s23, v28
    v_add_u32 v38, s23, v34
    v_add_u32 v37, s23, v29
    v_add_u32 v39, s23, v35
    s_add_u32 s23, s23, 16384
    s_and_b32 s23, s23, 0x1ffff
    ds_read_b64_tr_b16 v[112:113], v36 offset:0
    ds_read_b64_tr_b16 v[114:115], v36 offset:512
    v_mfma_f32_16x16x32_bf16 v[64:67], v[80:83], v[96:99], v[64:67]
    ds_read_b64_tr_b16 v[116:117], v37 offset:0
    v_mfma_f32_16x16x32_bf16 v[68:71], v[80:83], v[100:103], v[68:71]
    ds_read_b64_tr_b16 v[118:119], v37 offset:512
    ds_read_b128 v[128:131], v38 offset:0
    v_mfma_f32_16x16x32_bf16 v[72:75], v[84:87], v[96:99], v[72:75]
    ds_read_b128 v[132:135], v38 offset:2048
    v_mfma_f32_16x16x32_bf16 v[76:79], v[84:87], v[100:103], v[76:79]
    ds_read_b64_tr_b16 v[120:121], v36 offset:4096
    ds_read_b64_tr_b16 v[122:123], v36 offset:4608
    v_mfma_f32_16x16x32_bf16 v[64:67], v[88:91], v[104:107], v[64:67]
    ds_read_b64_tr_b16 v[124:125], v37 offset:4096
    v_mfma_f32_16x16x32_bf16 v[68:71], v[88:91], v[108:111], v[68:71]
    ds_read_b64_tr_b16 v[126:127], v37 offset:4608
    ds_read_b128 v[136:139], v39 offset:0
    v_mfma_f32_16x16x32_bf16 v[72:75], v[92:95], v[104:107], v[72:75]
    ds_read_b128 v[140:143], v39 offset:2048
    v_mfma_f32_16x16x32_bf16 v[76:79], v[92:95], v[108:111], v[76:79]
    s_waitcnt lgkmcnt(0)
    s_barrier
    v_add_u32 v36, s23, v28
    v_add_u32 v38, s23, v34
    v_add_u32 v37, s23, v29
    v_add_u32 v39, s23, v35
    s_add_u32 s23, s23, 16384
    s_and_b32 s23, s23, 0x1ffff
    ds_read_b64_tr_b16 v[80:81], v36 offset:0
    ds_read_b64_tr_b16 v[82:83], v36 offset:512
    v_mfma_f32_16x16x32_bf16 v[64:67], v[112:115], v[128:131], v[64:67]
    ds_read_b64_tr_b16 v[84:85], v37 offset:0
    v_mfma_f32_16x16x32_bf16 v[68:71], v[112:115], v[132:135], v[68:71]
    ds_read_b64_tr_b16 v[86:87], v37 offset:512
    ds_read_b128 v[96:99], v38 offset:0
    v_mfma_f32_16x16x32_bf16 v[72:75], v[116:119], v[128:131], v[72:75]
    ds_read_b128 v[100:103], v38 offset:2048
    v_mfma_f32_16x16x32_bf16 v[76:79], v[116:119], v[132:135], v[76:79]
    ds_read_b64_tr_b16 v[88:89], v36 offset:4096
    ds_read_b64_tr_b16 v[90:91], v36 offset:4608
    v_mfma_f32_16x16x32_bf16 v[64:67], v[120:123], v[136:139], v[64:67]
    ds_read_b64_tr_b16 v[92:93], v37 offset:4096
    v_mfma_f32_16x16x32_bf16 v[68:71], v[120:123], v[140:143], v[68:71]
    ds_read_b64_tr_b16 v[94:95], v37 offset:4608
    ds_read_b128 v[104:107], v39 offset:0
    v_mfma_f32_16x16x32_bf16 v[72:75], v[124:127], v[136:139], v[72:75]
    ds_read_b128 v[108:111], v39 offset:2048
    v_mfma_f32_16x16x32_bf16 v[76:79], v[124:127], v[140:143], v[76:79]
    s_waitcnt lgkmcnt(0)
    s_barrier
    v_add_u32 v36, s23, v28
    v_add_u32 v38, s23, v34
    v_add_u32 v37, s23, v29
    v_add_u32 v39, s23, v35
    s_add_u32 s23, s23, 16384
    s_and_b32 s23, s23, 0x1ffff
    ds_read_b64_tr_b16 v[112:113], v36 offset:0
    ds_read_b64_tr_b16 v[114:115], v36 offset:512
    v_mfma_f32_16x16x32_bf16 v[64:67], v[80:83], v[96:99], v[64:67]
    ds_read_b64_tr_b16 v[116:117], v37 offset:0
    v_mfma_f32_16x16x32_bf16 v[68:71], v[80:83], v[100:103], v[68:71]
    ds_read_b64_tr_b16 v[118:119], v37 offset:512
    ds_read_b128 v[128:131], v38 offset:0
    v_mfma_f32_16x16x32_bf16 v[72:75], v[84:87], v[96:99], v[72:75]
    ds_read_b128 v[132:135], v38 offset:2048
    v_mfma_f32_16x16x32_bf16 v[76:79], v[84:87], v[100:103], v[76:79]
    ds_read_b64_tr_b16 v[120:121], v36 offset:4096
    ds_read_b64_tr_b16 v[122:123], v36 offset:4608
    v_mfma_f32_16x16x32_bf16 v[64:67], v[88:91], v[104:107], v[64:67]
    ds_read_b64_tr_b16 v[124:125], v37 offset:4096
    v_mfma_f32_16x16x32_bf16 v[68:71], v[88:91], v[108:111], v[68:71]
    ds_read_b64_tr_b16 v[126:127], v37 offset:4608
    ds_read_b128 v[136:139], v39 offset:0
    v_mfma_f32_16x16x32_bf16 v[72:75], v[92:95], v[104:107], v[72:75]
    ds_read_b128 v[140:143], v39 offset:2048
    v_mfma_f32_16x16x32_bf16 v[76:79], v[92:95], v[108:111], v[76:79]
    s_waitcnt lgkmcnt(0)
C_ph3:
    s_lshl_b32 s91, s36, 11
    s_add_u32 s91, s91, 32768
    s_cmp_lg_u32 s25, 0
    s_cbranch_scc1 poll_done10
    s_mov_b32 s90, 0
    v_min_u32 v4, 27, v1
    v_lshlrev_b32 v4, 6, v4
    v_add_u32 v4, s91, v4
poll_loop10:
    buffer_load_dword v6, v4, s[92:95], 0 offen sc1
poll_chk10:
    s_waitcnt vmcnt(0)
    v_cmp_ne_u32 vcc, s88, v6
    s_add_u32 s90, s90, 1
    s_cmp_ge_u32 s90, 200000
    s_cbranch_scc1 poll_done10
    s_cmp_eq_u64 vcc, 0
    s_cbranch_scc1 poll_done10
    s_sleep 2
    s_branch poll_loop10
poll_done10:
    s_barrier
    v_add_u32 v36, s23, v28
    v_add_u32 v38, s23, v34
    v_add_u32 v37, s23, v29
    v_add_u32 v39, s23, v35
    s_add_u32 s23, s23, 16384
    s_and_b32 s23, s23, 0x1ffff
    ds_read_b64_tr_b16 v[80:81], v36 offset:0
    ds_read_b64_tr_b16 v[82:83], v36 offset:512
    v_mfma_f32_16x16x32_bf16 v[64:67], v[112:115], v[128:131], v[64:67]
    ds_read_b64_tr_b16 v[84:85], v37 offset:0
    v_mfma_f32_16x16x32_bf16 v[68:71], v[112:115], v[132:135], v[68:71]
    ds_read_b64_tr_b16 v[86:87], v37 offset:512
    ds_read_b128 v[96:99], v38 offset:0
    v_mfma_f32_16x16x32_bf16 v[72:75], v[116:119], v[128:131], v[72:75]
    ds_read_b128 v[100:103], v38 offset:2048
    v_mfma_f32_16x16x32_bf16 v[76:79], v[116:119], v[132:135], v[76:79]
    ds_read_b64_tr_b16 v[88:89], v36 offset:4096
    ds_read_b64_tr_b16 v[90:91], v36 offset:4608
    v_mfma_f32_16x16x32_bf16 v[64:67], v[120:123], v[136:139], v[64:67]
    ds_read_b64_tr_b16 v[92:93], v37 offset:4096
    v_mfma_f32_16x16x32_bf16 v[68:71], v[120:123], v[140:143], v[68:71]
    ds_read_b64_tr_b16 v[94:95], v37 offset:4608
    ds_read_b128 v[104:107], v39 offset:0
    v_mfma_f32_16x16x32_bf16 v[72:75], v[124:127], v[136:139], v[72:75]
    ds_read_b128 v[108:111], v39 offset:2048
    v_mfma_f32_16x16x32_bf16 v[76:79], v[124:127], v[140:143], v[76:79]
    s_waitcnt lgkmcnt(0)
    s_barrier
    v_add_u32 v36, s23, v28
    v_add_u32 v38, s23, v34
    v_add_u32 v37, s23, v29
    v_add_u32 v39, s23, v35
    s_add_u32 s23, s23, 16384
    s_and_b32 s23, s23, 0x1ffff
    ds_read_b64_tr_b16 v[112:113], v36 offset:0
    ds_read_b64_tr_b16 v[114:115], v36 offset:512
    v_mfma_f32_16x16x32_bf16 v[64:67], v[80:83], v[96:99], v[64:67]
    ds_read_b64_tr_b16 v[116:117], v37 offset:0
    v_mfma_f32_16x16x32_bf16 v[68:71], v[80:83], v[100:103], v[68:71]
    ds_read_b64_tr_b16 v[118:119], v37 offset:512
    ds_read_b128 v[128:131], v38 offset:0
    v_mfma_f32_16x16x32_bf16 v[72:75], v[84:87], v[96:99], v[72:75]
    ds_read_b128 v[132:135], v38 offset:2048
    v_mfma_f32_16x16x32_bf16 v[76:79], v[84:87], v[100:103], v[76:79]
    ds_read_b64_tr_b16 v[120:121], v36 offset:4096
    ds_read_b64_tr_b16 v[122:123], v36 offset:4608
    v_mfma_f32_16x16x32_bf16 v[64:67], v[88:91], v[104:107], v[64:67]
    ds_read_b64_tr_b16 v[124:125], v37 offset:4096
    v_mfma_f32_16x16x32_bf16 v[68:71], v[88:91], v[108:111], v[68:71]
    ds_read_b64_tr_b16 v[126:127], v37 offset:4608
    ds_read_b128 v[136:139], v39 offset:0
    v_mfma_f32_16x16x32_bf16 v[72:75], v[92:95], v[104:107], v[72:75]
    ds_read_b128 v[140:143], v39 offset:2048
    v_mfma_f32_16x16x32_bf16 v[76:79], v[92:95], v[108:111], v[76:79]
    s_waitcnt lgkmcnt(0)
    s_barrier
    v_add_u32 v36, s23, v28
    v_add_u32 v38, s23, v34
    v_add_u32 v37, s23, v29
    v_add_u32 v39, s23, v35
    s_add_u32 s23, s23, 16384
    s_and_b32 s23, s23, 0x1ffff
    ds_read_b64_tr_b16 v[80:81], v36 offset:0
    ds_read_b64_tr_b16 v[82:83], v36 offset:512
    v_mfma_f32_16x16x32_bf16 v[64:67], v[112:115], v[128:131], v[64:67]
    ds_read_b64_tr_b16 v[84:85], v37 offset:0
    v_mfma_f32_16x16x32_bf16 v[68:71], v[112:115], v[132:135], v[68:71]
    ds_read_b64_tr_b16 v[86:87], v37 offset:512
    ds_read_b128 v[96:99], v38 offset:0
    v_mfma_f32_16x16x32_bf16 v[72:75], v[116:119], v[128:131], v[72:75]
    ds_read_b128 v[100:103], v38 offset:2048
    v_mfma_f32_16x16x32_bf16 v[76:79], v[116:119], v[132:135], v[76:79]
    ds_read_b64_tr_b16 v[88:89], v36 offset:4096
    ds_read_b64_tr_b16 v[90:91], v36 offset:4608
    v_mfma_f32_16x16x32_bf16 v[64:67], v[120:123], v[136:139], v[64:67]
    ds_read_b64_tr_b16 v[92:93], v37 offset:4096
    v_mfma_f32_16x16x32_bf16 v[68:71], v[120:123], v[140:143], v[68:71]
    ds_read_b64_tr_b16 v[94:95], v37 offset:4608
    ds_read_b128 v[104:107], v39 offset:0
    v_mfma_f32_16x16x32_bf16 v[72:75], v[124:127], v[136:139], v[72:75]
    ds_read_b128 v[108:111], v39 offset:2048
    v_mfma_f32_16x16x32_bf16 v[76:79], v[124:127], v[140:143], v[76:79]
    s_waitcnt lgkmcnt(0)
    s_barrier
    v_add_u32 v36, s23, v28
    v_add_u32 v38, s23, v34
    v_add_u32 v37, s23, v29
    v_add_u32 v39, s23, v35
    s_add_u32 s23, s23, 16384
    s_and_b32 s23, s23, 0x1ffff
    ds_read_b64_tr_b16 v[112:113], v36 offset:0
    ds_read_b64_tr_b16 v[114:115], v36 offset:512
    v_mfma_f32_16x16x32_bf16 v[64:67], v[80:83], v[96:99], v[64:67]
    ds_read_b64_tr_b16 v[116:117], v37 offset:0
    v_mfma_f32_16x16x32_bf16 v[68:71], v[80:83], v[100:103], v[68:71]
    ds_read_b64_tr_b16 v[118:119], v37 offset:512
    ds_read_b128 v[128:131], v38 offset:0
    v_mfma_f32_16x16x32_bf16 v[72:75], v[84:87], v[96:99], v[72:75]
    ds_read_b128 v[132:135], v38 offset:2048
    v_mfma_f32_16x16x32_bf16 v[76:79], v[84:87], v[100:103], v[76:79]
    ds_read_b64_tr_b16 v[120:121], v36 offset:4096
    ds_read_b64_tr_b16 v[122:123], v36 offset:4608
    v_mfma_f32_16x16x32_bf16 v[64:67], v[88:91], v[104:107], v[64:67]
    ds_read_b64_tr_b16 v[124:125], v37 offset:4096
    v_mfma_f32_16x16x32_bf16 v[68:71], v[88:91], v[108:111], v[68:71]
    ds_read_b64_tr_b16 v[126:127], v37 offset:4608
    ds_read_b128 v[136:139], v39 offset:0
    v_mfma_f32_16x16x32_bf16 v[72:75], v[92:95], v[104:107], v[72:75]
    ds_read_b128 v[140:143], v39 offset:2048
    v_mfma_f32_16x16x32_bf16 v[76:79], v[92:95], v[108:111], v[76:79]
    s_waitcnt lgkmcnt(0)
    s_barrier
    v_add_u32 v36, s23, v32
    v_add_u32 v38, s23, v30
    v_add_u32 v37, s23, v33
    v_add_u32 v39, s23, v31
    s_add_u32 s23, s23, 16384
    s_and_b32 s23, s23, 0x1ffff
    ds_read_b128 v[80:83], v36 offset:0
    ds_read_b128 v[84:87], v36 offset:2048
    v_mfma_f32_16x16x32_bf16 v[64:67], v[112:115], v[128:131], v[64:67]
    ds_read_b64_tr_b16 v[96:97], v38 offset:0
    v_mfma_f32_16x16x32_bf16 v[68:71], v[112:115], v[132:135], v[68:71]
    ds_read_b64_tr_b16 v[98:99], v38 offset:512
    ds_read_b64_tr_b16 v[100:101], v39 offset:0
    v_mfma_f32_16x16x32_bf16 v[72:75], v[116:119], v[128:131], v[72:75]
    ds_read_b64_tr_b16 v[102:103], v39 offset:512
    v_mfma_f32_16x16x32_bf16 v[76:79], v[116:119], v[132:135], v[76:79]
    ds_read_b128 v[88:91], v37 offset:0
    ds_read_b128 v[92:95], v37 offset:2048
    v_mfma_f32_16x16x32_bf16 v[64:67], v[120:123], v[136:139], v[64:67]
    ds_read_b64_tr_b16 v[104:105], v38 offset:4096
    v_mfma_f32_16x16x32_bf16 v[68:71], v[120:123], v[140:143], v[68:71]
    ds_read_b64_tr_b16 v[106:107], v38 offset:4608
    ds_read_b64_tr_b16 v[108:109], v39 offset:4096
    v_mfma_f32_16x16x32_bf16 v[72:75], v[124:127], v[136:139], v[72:75]
    ds_read_b64_tr_b16 v[110:111], v39 offset:4608
    v_mfma_f32_16x16x32_bf16 v[76:79], v[124:127], v[140:143], v[76:79]
    s_waitcnt lgkmcnt(0)
    s_mov_b32 s24, 0
CG_loop2:
    s_barrier
    v_add_u32 v36, s23, v32
    v_add_u32 v38, s23, v30
    v_add_u32 v37, s23, v33
    v_add_u32 v39, s23, v31
    s_add_u32 s23, s23, 16384
    s_and_b32 s23, s23, 0x1ffff
    ds_read_b128 v[112:115], v36 offset:0
    ds_read_b128 v[116:119], v36 offset:2048
    v_mfma_f32_16x16x32_bf16 v[48:51], v[80:83], v[96:99], v[48:51]
    ds_read_b64_tr_b16 v[128:129], v38 offset:0
    v_mfma_f32_16x16x32_bf16 v[52:55], v[80:83], v[100:103], v[52:55]
    ds_read_b64_tr_b16 v[130:131], v38 offset:512
    ds_read_b64_tr_b16 v[132:133], v39 offset:0
    v_mfma_f32_16x16x32_bf16 v[56:59], v[84:87], v[96:99], v[56:59]
    ds_read_b64_tr_b16 v[134:135], v39 offset:512
    v_mfma_f32_16x16x32_bf16 v[60:63], v[84:87], v[100:103], v[60:63]
    ds_read_b128 v[120:123], v37 offset:0
    ds_read_b128 v[124:127], v37 offset:2048
    v_mfma_f32_16x16x32_bf16 v[48:51], v[88:91], v[104:107], v[48:51]
    ds_read_b64_tr_b16 v[136:137], v38 offset:4096
    v_mfma_f32_16x16x32_bf16 v[52:55], v[88:91], v[108:111], v[52:55]
    ds_read_b64_tr_b16 v[138:139], v38 offset:4608
    ds_read_b64_tr_b16 v[140:141], v39 offset:4096
    v_mfma_f32_16x16x32_bf16 v[56:59], v[92:95], v[104:107], v[56:59]
    ds_read_b64_tr_b16 v[142:143], v39 offset:4608
    v_mfma_f32_16x16x32_bf16 v[60:63], v[92:95], v[108:111], v[60:63]
    s_waitcnt lgkmcnt(0)
    s_barrier
    v_add_u32 v36, s23, v32
    v_add_u32 v38, s23, v30
    v_add_u32 v37, s23, v33
    v_add_u32 v39, s23, v31
    s_add_u32 s23, s23, 16384
    s_and_b32 s23, s23, 0x1ffff
    ds_read_b128 v[80:83], v36 offset:0
    ds_read_b128 v[84:87], v36 offset:2048
    v_mfma_f32_16x16x32_bf16 v[48:51], v[112:115], v[128:131], v[48:51]
    ds_read_b64_tr_b16 v[96:97], v38 offset:0
    v_mfma_f32_16x16x32_bf16 v[52:55], v[112:115], v[132:135], v[52:55]
    ds_read_b64_tr_b16 v[98:99], v38 offset:512
    ds_read_b64_tr_b16 v[100:101], v39 offset:0
    v_mfma_f32_16x16x32_bf16 v[56:59], v[116:119], v[128:131], v[56:59]
    ds_read_b64_tr_b16 v[102:103], v39 offset:512
    v_mfma_f32_16x16x32_bf16 v[60:63], v[116:119], v[132:135], v[60:63]
    ds_read_b128 v[88:91], v37 offset:0
    ds_read_b128 v[92:95], v37 offset:2048
    v_mfma_f32_16x16x32_bf16 v[48:51], v[120:123], v[136:139], v[48:51]
    ds_read_b64_tr_b16 v[104:105], v38 offset:4096
    v_mfma_f32_16x16x32_bf16 v[52:55], v[120:123], v[140:143], v[52:55]
    ds_read_b64_tr_b16 v[106:107], v38 offset:4608
    ds_read_b64_tr_b16 v[108:109], v39 offset:4096
    v_mfma_f32_16x16x32_bf16 v[56:59], v[124:127], v[136:139], v[56:59]
    ds_read_b64_tr_b16 v[110:111], v39 offset:4608
    v_mfma_f32_16x16x32_bf16 v[60:63], v[124:127], v[140:143], v[60:63]
    s_waitcnt lgkmcnt(0)
    s_add_u32 s24, s24, 1
    s_cmp_lt_u32 s24, 13
    s_cbranch_scc1 CG_loop2
    s_barrier
    v_add_u32 v36, s23, v32
    v_add_u32 v38, s23, v30
    v_add_u32 v37, s23, v33
    v_add_u32 v39, s23, v31
    s_add_u32 s23, s23, 16384
    s_and_b32 s23, s23, 0x1ffff
    ds_read_b128 v[112:115], v36 offset:0
    ds_read_b128 v[116:119], v36 offset:2048
    v_mfma_f32_16x16x32_bf16 v[48:51], v[80:83], v[96:99], v[48:51]
    ds_read_b64_tr_b16 v[128:129], v38 offset:0
    v_mfma_f32_16x16x32_bf16 v[52:55], v[80:83], v[100:103], v[52:55]
    ds_read_b64_tr_b16 v[130:131], v38 offset:512
    ds_read_b64_tr_b16 v[132:133], v39 offset:0
    v_mfma_f32_16x16x32_bf16 v[56:59], v[84:87], v[96:99], v[56:59]
    ds_read_b64_tr_b16 v[134:135], v39 offset:512
    v_mfma_f32_16x16x32_bf16 v[60:63], v[84:87], v[100:103], v[60:63]
    ds_read_b128 v[120:123], v37 offset:0
    ds_read_b128 v[124:127], v37 offset:2048
    v_mfma_f32_16x16x32_bf16 v[48:51], v[88:91], v[104:107], v[48:51]
    ds_read_b64_tr_b16 v[136:137], v38 offset:4096
    v_mfma_f32_16x16x32_bf16 v[52:55], v[88:91], v[108:111], v[52:55]
    ds_read_b64_tr_b16 v[138:139], v38 offset:4608
    ds_read_b64_tr_b16 v[140:141], v39 offset:4096
    v_mfma_f32_16x16x32_bf16 v[56:59], v[92:95], v[104:107], v[56:59]
    ds_read_b64_tr_b16 v[142:143], v39 offset:4608
    v_mfma_f32_16x16x32_bf16 v[60:63], v[92:95], v[108:111], v[60:63]
    s_waitcnt lgkmcnt(0)
    s_barrier
    v_mfma_f32_16x16x32_bf16 v[48:51], v[112:115], v[128:131], v[48:51]
    v_mfma_f32_16x16x32_bf16 v[52:55], v[112:115], v[132:135], v[52:55]
    v_mfma_f32_16x16x32_bf16 v[56:59], v[116:119], v[128:131], v[56:59]
    v_mfma_f32_16x16x32_bf16 v[60:63], v[116:119], v[132:135], v[60:63]
    v_mfma_f32_16x16x32_bf16 v[48:51], v[120:123], v[136:139], v[48:51]
    v_mfma_f32_16x16x32_bf16 v[52:55], v[120:123], v[140:143], v[52:55]
    v_mfma_f32_16x16x32_bf16 v[56:59], v[124:127], v[136:139], v[56:59]
    v_mfma_f32_16x16x32_bf16 v[60:63], v[124:127], v[140:143], v[60:63]
    s_waitcnt vmcnt(0)
    s_nop 7
    v_sub_f32 v156, 1.0, v20
    v_cvt_pk_bf16_f32 v156, v156, v156
    v_lshlrev_b32 v156, 16, v156
    v_lshlrev_b32 v157, 16, v22
    v_cvt_pk_bf16_f32 v144, v48, v49
    v_cvt_pk_bf16_f32 v145, v50, v51
    v_lshlrev_b32 v146, 16, v144
    v_and_b32 v147, 0xffff0000, v144
    v_lshlrev_b32 v148, 16, v145
    v_and_b32 v149, 0xffff0000, v145
    v_add_f32 v146, v146, v157
    v_add_f32 v147, v147, v157
    v_add_f32 v148, v148, v157
    v_add_f32 v149, v149, v157
    v_cvt_pk_bf16_f32 v144, v146, v147
    v_cvt_pk_bf16_f32 v145, v148, v149
    v_lshlrev_b32 v146, 16, v144
    v_and_b32 v147, 0xffff0000, v144
    v_lshlrev_b32 v148, 16, v145
    v_and_b32 v149, 0xffff0000, v145
    v_mul_f32 v146, v146, v156
    v_mul_f32 v147, v147, v156
    v_mul_f32 v148, v148, v156
    v_mul_f32 v149, v149, v156
    v_cvt_pk_bf16_f32 v144, v146, v147
    v_cvt_pk_bf16_f32 v145, v148, v149
    v_lshlrev_b32 v146, 16, v144
    v_and_b32 v147, 0xffff0000, v144
    v_lshlrev_b32 v148, 16, v145
    v_and_b32 v149, 0xffff0000, v145
    v_cvt_pk_bf16_f32 v144, v64, v65
    v_cvt_pk_bf16_f32 v145, v66, v67
    v_lshlrev_b32 v150, 16, v144
    v_and_b32 v151, 0xffff0000, v144
    v_lshlrev_b32 v152, 16, v145
    v_and_b32 v153, 0xffff0000, v145
    v_mul_f32 v150, v150, v20
    v_mul_f32 v151, v151, v20
    v_mul_f32 v152, v152, v20
    v_mul_f32 v153, v153, v20
    v_cvt_pk_bf16_f32 v144, v150, v151
    v_cvt_pk_bf16_f32 v145, v152, v153
    v_lshlrev_b32 v150, 16, v144
    v_and_b32 v151, 0xffff0000, v144
    v_lshlrev_b32 v152, 16, v145
    v_and_b32 v153, 0xffff0000, v145
    v_add_f32 v146, v146, v150
    v_add_f32 v147, v147, v151
    v_add_f32 v148, v148, v152
    v_add_f32 v149, v149, v153
    v_cvt_pk_bf16_f32 v160, v146, v147
    v_cvt_pk_bf16_f32 v161, v148, v149
    buffer_store_dwordx2 v[160:161], v24, s[84:87], 0 offen offset:0
    v_cvt_pk_bf16_f32 v144, v56, v57
    v_cvt_pk_bf16_f32 v145, v58, v59
    v_lshlrev_b32 v146, 16, v144
    v_and_b32 v147, 0xffff0000, v144
    v_lshlrev_b32 v148, 16, v145
    v_and_b32 v149, 0xffff0000, v145
    v_add_f32 v146, v146, v157
    v_add_f32 v147, v147, v157
    v_add_f32 v148, v148, v157
    v_add_f32 v149, v149, v157
    v_cvt_pk_bf16_f32 v144, v146, v147
    v_cvt_pk_bf16_f32 v145, v148, v149
    v_lshlrev_b32 v146, 16, v144
    v_and_b32 v147, 0xffff0000, v144
    v_lshlrev_b32 v148, 16, v145
    v_and_b32 v149, 0xffff0000, v145
    v_mul_f32 v146, v146, v156
    v_mul_f32 v147, v147, v156
    v_mul_f32 v148, v148, v156
    v_mul_f32 v149, v149, v156
    v_cvt_pk_bf16_f32 v144, v146, v147
    v_cvt_pk_bf16_f32 v145, v148, v149
    v_lshlrev_b32 v146, 16, v144
    v_and_b32 v147, 0xffff0000, v144
    v_lshlrev_b32 v148, 16, v145
    v_and_b32 v149, 0xffff0000, v145
    v_cvt_pk_bf16_f32 v144, v72, v73
    v_cvt_pk_bf16_f32 v145, v74, v75
    v_lshlrev_b32 v150, 16, v144
    v_and_b32 v151, 0xffff0000, v144
    v_lshlrev_b32 v152, 16, v145
    v_and_b32 v153, 0xffff0000, v145
    v_mul_f32 v150, v150, v20
    v_mul_f32 v151, v151, v20
    v_mul_f32 v152, v152, v20
    v_mul_f32 v153, v153, v20
    v_cvt_pk_bf16_f32 v144, v150, v151
    v_cvt_pk_bf16_f32 v145, v152, v153
    v_lshlrev_b32 v150, 16, v144
    v_and_b32 v151, 0xffff0000, v144
    v_lshlrev_b32 v152, 16, v145
    v_and_b32 v153, 0xffff0000, v145
    v_add_f32 v146, v146, v150
    v_add_f32 v147, v147, v151
    v_add_f32 v148, v148, v152
    v_add_f32 v149, v149, v153
    v_cvt_pk_bf16_f32 v162, v146, v147
    v_cvt_pk_bf16_f32 v163, v148, v149
    buffer_store_dwordx2 v[162:163], v24, s[84:87], 0 offen offset:32
    v_sub_f32 v156, 1.0, v21
    v_cvt_pk_bf16_f32 v156, v156, v156
    v_lshlrev_b32 v156, 16, v156
    v_lshlrev_b32 v157, 16, v23
    v_cvt_pk_bf16_f32 v144, v52, v53
    v_cvt_pk_bf16_f32 v145, v54, v55
    v_lshlrev_b32 v146, 16, v144
    v_and_b32 v147, 0xffff0000, v144
    v_lshlrev_b32 v148, 16, v145
    v_and_b32 v149, 0xffff0000, v145
    v_add_f32 v146, v146, v157
    v_add_f32 v147, v147, v157
    v_add_f32 v148, v148, v157
    v_add_f32 v149, v149, v157
    v_cvt_pk_bf16_f32 v144, v146, v147
    v_cvt_pk_bf16_f32 v145, v148, v149
    v_lshlrev_b32 v146, 16, v144
    v_and_b32 v147, 0xffff0000, v144
    v_lshlrev_b32 v148, 16, v145
    v_and_b32 v149, 0xffff0000, v145
    v_mul_f32 v146, v146, v156
    v_mul_f32 v147, v147, v156
    v_mul_f32 v148, v148, v156
    v_mul_f32 v149, v149, v156
    v_cvt_pk_bf16_f32 v144, v146, v147
    v_cvt_pk_bf16_f32 v145, v148, v149
    v_lshlrev_b32 v146, 16, v144
    v_and_b32 v147, 0xffff0000, v144
    v_lshlrev_b32 v148, 16, v145
    v_and_b32 v149, 0xffff0000, v145
    v_cvt_pk_bf16_f32 v144, v68, v69
    v_cvt_pk_bf16_f32 v145, v70, v71
    v_lshlrev_b32 v150, 16, v144
    v_and_b32 v151, 0xffff0000, v144
    v_lshlrev_b32 v152, 16, v145
    v_and_b32 v153, 0xffff0000, v145
    v_mul_f32 v150, v150, v21
    v_mul_f32 v151, v151, v21
    v_mul_f32 v152, v152, v21
    v_mul_f32 v153, v153, v21
    v_cvt_pk_bf16_f32 v144, v150, v151
    v_cvt_pk_bf16_f32 v145, v152, v153
    v_lshlrev_b32 v150, 16, v144
    v_and_b32 v151, 0xffff0000, v144
    v_lshlrev_b32 v152, 16, v145
    v_and_b32 v153, 0xffff0000, v145
    v_add_f32 v146, v146, v150
    v_add_f32 v147, v147, v151
    v_add_f32 v148, v148, v152
    v_add_f32 v149, v149, v153
    v_cvt_pk_bf16_f32 v164, v146, v147
    v_cvt_pk_bf16_f32 v165, v148, v149
    buffer_store_dwordx2 v[164:165], v25, s[84:87], 0 offen offset:0
    v_cvt_pk_bf16_f32 v144, v60, v61
    v_cvt_pk_bf16_f32 v145, v62, v63
    v_lshlrev_b32 v146, 16, v144
    v_and_b32 v147, 0xffff0000, v144
    v_lshlrev_b32 v148, 16, v145
    v_and_b32 v149, 0xffff0000, v145
    v_add_f32 v146, v146, v157
    v_add_f32 v147, v147, v157
    v_add_f32 v148, v148, v157
    v_add_f32 v149, v149, v157
    v_cvt_pk_bf16_f32 v144, v146, v147
    v_cvt_pk_bf16_f32 v145, v148, v149
    v_lshlrev_b32 v146, 16, v144
    v_and_b32 v147, 0xffff0000, v144
    v_lshlrev_b32 v148, 16, v145
    v_and_b32 v149, 0xffff0000, v145
    v_mul_f32 v146, v146, v156
    v_mul_f32 v147, v147, v156
    v_mul_f32 v148, v148, v156
    v_mul_f32 v149, v149, v156
    v_cvt_pk_bf16_f32 v144, v146, v147
    v_cvt_pk_bf16_f32 v145, v148, v149
    v_lshlrev_b32 v146, 16, v144
    v_and_b32 v147, 0xffff0000, v144
    v_lshlrev_b32 v148, 16, v145
    v_and_b32 v149, 0xffff0000, v145
    v_cvt_pk_bf16_f32 v144, v76, v77
    v_cvt_pk_bf16_f32 v145, v78, v79
    v_lshlrev_b32 v150, 16, v144
    v_and_b32 v151, 0xffff0000, v144
    v_lshlrev_b32 v152, 16, v145
    v_and_b32 v153, 0xffff0000, v145
    v_mul_f32 v150, v150, v21
    v_mul_f32 v151, v151, v21
    v_mul_f32 v152, v152, v21
    v_mul_f32 v153, v153, v21
    v_cvt_pk_bf16_f32 v144, v150, v151
    v_cvt_pk_bf16_f32 v145, v152, v153
    v_lshlrev_b32 v150, 16, v144
    v_and_b32 v151, 0xffff0000, v144
    v_lshlrev_b32 v152, 16, v145
    v_and_b32 v153, 0xffff0000, v145
    v_add_f32 v146, v146, v150
    v_add_f32 v147, v147, v151
    v_add_f32 v148, v148, v152
    v_add_f32 v149, v149, v153
    v_cvt_pk_bf16_f32 v166, v146, v147
    v_cvt_pk_bf16_f32 v167, v148, v149
    buffer_store_dwordx2 v[166:167], v25, s[84:87], 0 offen offset:32
L_done:
    s_endpgm
L_code_end:
    .section .rodata,"a"
    .p2align 6
    .amdhsa_kernel gated_mix__sliding_local_dilated__mixer_token_mlp__prompt_kernel
      .amdhsa_next_free_vgpr 168
      .amdhsa_next_free_sgpr 102
      .amdhsa_accum_offset 168
      .amdhsa_group_segment_fixed_size 0
      .amdhsa_kernarg_size 96
      .amdhsa_user_sgpr_count 2
      .amdhsa_user_sgpr_kernarg_segment_ptr 1
      .amdhsa_system_sgpr_workgroup_id_x 1
    .end_amdhsa_kernel
```
